```python
import torch

def _softmax(x, axis=-1):
    return torch.softmax(x, dim=axis)
def _gelu(x):
    return torch.nn.functional.gelu(x, approximate="tanh")
def _silu(x):
    return torch.nn.functional.silu(x)
def _sigmoid(x):
    return torch.sigmoid(x)
def _layernorm(x, axis=-1, eps=1e-5):
    m = x.mean(dim=axis, keepdim=True)
    v = x.var(dim=axis, keepdim=True, unbiased=False)
    return (x - m) / torch.sqrt(v + eps)
def _scatter_add(tgt, idx, src, axis=0):
    return tgt.clone().index_add_(axis, idx, src)
def _segment_sum(src, seg, n):
    out = torch.zeros((n,) + src.shape[1:], dtype=src.dtype)
    return out.index_add_(0, seg, src)
def _pad(x, pw):
    flat = tuple(v for pair in reversed(pw) for v in pair)
    return torch.nn.functional.pad(x, flat)

kernel_name = 'parallel_sum__sliding_block_cached__dense_activation_silu__decode'

def setup_inputs():

    _w = (lambda a: (lambda t: t.to(torch.bfloat16) if t.is_floating_point() else t)(torch.as_tensor(a)))
    def _A_setup():
        B, Sq, D = 4, 1, 512
        Hq, Hkv, Sk, Dh = 32, 32, 8192, 128
        assert Hq % Hkv == 0, (Hq, Hkv)
        return {
            "x": _w((lambda *s: torch.randn(*s, dtype=torch.bfloat16) * 0.05)(B, Sq, D)),
            "k_cache": _w((lambda *s: torch.randn(*s, dtype=torch.bfloat16) * 3.2)(B, Hkv, Sk, Dh)),
            "v_cache": _w((lambda *s: torch.randn(*s, dtype=torch.bfloat16) * 0.8)(B, Hkv, Sk, Dh)),
            "wq": _w((lambda *s: torch.randn(*s, dtype=torch.bfloat16) * 3.2)(D, Hq * Dh) * (D ** -0.5)),
            "wo": _w((lambda *s: torch.randn(*s, dtype=torch.bfloat16) * 0.8)(Hq * Dh, D) * ((Hq * Dh) ** -0.5)),
        }
    _A_in = _A_setup()

    def _B_setup():
        B, S, D, F = 4, 1, 512, 1376
        return {
            "x": _w((lambda *s: torch.randn(*s, dtype=torch.bfloat16) * 0.05)(B, S, D)),
            "w1": _w((lambda *s: torch.randn(*s, dtype=torch.bfloat16) * 3.2)(D, F) * (D ** -0.5)),
            "w2": _w((lambda *s: torch.randn(*s, dtype=torch.bfloat16) * 0.4)(F, D) * (F ** -0.5)),
        }
    _B_in = _B_setup()

    return {
        "A_x": _A_in["x"],
        "A_k_cache": _A_in["k_cache"],
        "A_v_cache": _A_in["v_cache"],
        "A_wq": _A_in["wq"],
        "A_wo": _A_in["wo"],
        "B_x": _B_in["x"],
        "B_w1": _B_in["w1"],
        "B_w2": _B_in["w2"],
    }

def reference(A_x, A_k_cache, A_v_cache, A_wq, A_wo, B_x, B_w1, B_w2):
    def _A_ref(x, k_cache, v_cache, wq, wo):
        B, Sq, D = x.shape
        Hq, Dh = 32, 128
        Hkv, Sk = k_cache.shape[1], k_cache.shape[2]
        W = min(4096, max(256, Sk // 4))
        rep = Hq // Hkv
        q = (lambda x, *d: x.permute(*d))((x @ wq).reshape(B, Sq, Hq, Dh), 0, 2, 1, 3)
        k = (lambda x, n, axis: torch.repeat_interleave(x, n, dim=axis))(k_cache[:, :, Sk - W:, :], rep, axis=1)
        v = (lambda x, n, axis: torch.repeat_interleave(x, n, dim=axis))(v_cache[:, :, Sk - W:, :], rep, axis=1)
        scores = torch.einsum("bhqd,bhkd->bhqk", q, k) * (Dh ** -0.5)
        p = _softmax(scores, axis=-1)
        o = torch.einsum("bhqk,bhkd->bhqd", p, v)
        return (lambda x, *d: x.permute(*d))(o, 0, 2, 1, 3).reshape(B, Sq, Hq * Dh) @ wo

    def _B_ref(x, w1, w2):
        h = torch.einsum("bsd,df->bsf", x, w1)
        h = _silu(h)
        out = torch.einsum("bsf,fd->bsd", h, w2)
        return out

    x = A_x
    xn = _layernorm(x, axis=-1)
    return x + _A_ref(xn, A_k_cache, A_v_cache, A_wq, A_wo) + _B_ref(xn, B_w1, B_w2)
```

```asm
; @launch grid=(256,1,1) block=(512,1,1) lds=147456
.amdgcn_target "amdgcn-amd-amdhsa--gfx950"
.text
.globl parallel_sum__sliding_block_cached__dense_activation_silu__decode_kernel
.p2align 8
.type parallel_sum__sliding_block_cached__dense_activation_silu__decode_kernel,@function
parallel_sum__sliding_block_cached__dense_activation_silu__decode_kernel:
  s_cmp_ge_u32 s2, 256
  s_cbranch_scc1 L_end
  s_load_dwordx2 s[10:11], s[0:1], 8
  s_load_dwordx2 s[12:13], s[0:1], 16
  v_lshrrev_b32 v1, 6, v0
  v_and_b32 v0, 63, v0
  v_readfirstlane_b32 s3, v1
  s_and_b32 s4, s2, 7
  s_lshr_b32 s5, s2, 3
  s_lshr_b32 s6, s5, 3
  s_lshl_b32 s30, s4, 2
  s_add_u32 s30, s30, s6
  s_lshr_b32 s31, s5, 1
  s_and_b32 s31, s31, 3
  s_and_b32 s32, s5, 1
  v_lshlrev_b32 v1, 4, v0
  s_cmp_ge_u32 s3, 4
  s_cbranch_scc1 L_B
  s_lshl_b32 s4, s31, 5
  s_add_u32 s4, s4, s30
  s_lshl_b32 s4, s4, 21
  s_lshl_b32 s5, s32, 18
  s_add_u32 s4, s4, s5
  s_add_u32 s4, s4, 0x180000
  s_mul_i32 s5, s3, 4096
  s_add_u32 s4, s4, s5
  s_mov_b32 s38, 0x40000
  s_mov_b32 s39, 0x20000
  s_mov_b32 s42, 0x40000
  s_mov_b32 s43, 0x20000
  s_mul_i32 s75, s3, 32768
  s_add_u32 s75, s75, 16384
  s_waitcnt lgkmcnt(0)
  s_add_u32 s36, s10, s4
  s_addc_u32 s37, s11, 0
  s_add_u32 s40, s12, s4
  s_addc_u32 s41, s13, 0
  s_mov_b64 exec, 1
  buffer_load_dword v26, v1, s[40:43], 0 offen nt
  s_mov_b64 exec, -1
  s_add_u32 m0, s75, 0
  s_mov_b32 s72, 0
  buffer_load_dwordx4 v1, s[36:39], s72 offen nt lds
  s_add_u32 m0, s75, 1024
  s_mov_b32 s72, 1024
  buffer_load_dwordx4 v1, s[36:39], s72 offen nt lds
  s_add_u32 m0, s75, 2048
  s_mov_b32 s72, 2048
  buffer_load_dwordx4 v1, s[36:39], s72 offen nt lds
  s_add_u32 m0, s75, 3072
  s_mov_b32 s72, 3072
  buffer_load_dwordx4 v1, s[36:39], s72 offen nt lds
  s_add_u32 m0, s75, 4096
  s_mov_b32 s72, 16384
  buffer_load_dwordx4 v1, s[36:39], s72 offen nt lds
  s_and_b32 s4, s2, 7
  s_lshr_b32 s5, s2, 3
  s_lshr_b32 s6, s5, 3
  s_and_b32 s35, s5, 7
  s_lshl_b32 s6, s6, 1
  s_add_u32 s6, s6, s32
  s_mul_i32 s7, s4, 43
  s_lshr_b32 s7, s7, 3
  s_add_u32 s5, s4, 1
  s_mul_i32 s5, s5, 43
  s_lshr_b32 s5, s5, 3
  s_add_u32 s33, s7, s6
  s_cmp_lt_u32 s33, s5
  s_cselect_b32 s33, s33, 63
  s_lshl_b32 s34, s30, 1
  s_add_u32 s34, s34, s32
  s_mov_b32 s76, 0x3db504f3
  s_mov_b32 s77, 0x3fb8aa3b
  s_mov_b32 s78, 0xffff0000
  s_barrier
  s_add_u32 m0, s75, 5120
  s_mov_b32 s72, 17408
  buffer_load_dwordx4 v1, s[36:39], s72 offen nt lds
  s_waitcnt vmcnt(4)
  s_add_u32 m0, s75, 6144
  s_mov_b32 s72, 18432
  buffer_load_dwordx4 v1, s[36:39], s72 offen nt lds
  s_waitcnt vmcnt(4)
  s_add_u32 m0, s75, 7168
  s_mov_b32 s72, 19456
  buffer_load_dwordx4 v1, s[36:39], s72 offen nt lds
  s_waitcnt vmcnt(4)
  s_add_u32 m0, s75, 8192
  s_mov_b32 s72, 32768
  buffer_load_dwordx4 v1, s[36:39], s72 offen nt lds
  s_waitcnt vmcnt(4)
  s_add_u32 m0, s75, 9216
  s_mov_b32 s72, 33792
  buffer_load_dwordx4 v1, s[36:39], s72 offen nt lds
  s_waitcnt vmcnt(4)
  s_add_u32 m0, s75, 10240
  s_mov_b32 s72, 34816
  buffer_load_dwordx4 v1, s[36:39], s72 offen nt lds
  s_waitcnt vmcnt(4)
  s_add_u32 m0, s75, 11264
  s_mov_b32 s72, 35840
  buffer_load_dwordx4 v1, s[36:39], s72 offen nt lds
  s_waitcnt vmcnt(4)
  s_add_u32 m0, s75, 12288
  s_mov_b32 s72, 49152
  buffer_load_dwordx4 v1, s[36:39], s72 offen nt lds
  s_waitcnt vmcnt(4)
  s_add_u32 m0, s75, 13312
  s_mov_b32 s72, 50176
  buffer_load_dwordx4 v1, s[36:39], s72 offen nt lds
  s_waitcnt vmcnt(4)
  s_add_u32 m0, s75, 14336
  s_mov_b32 s72, 51200
  buffer_load_dwordx4 v1, s[36:39], s72 offen nt lds
  s_waitcnt vmcnt(4)
  s_add_u32 m0, s75, 15360
  s_mov_b32 s72, 52224
  buffer_load_dwordx4 v1, s[36:39], s72 offen nt lds
  s_waitcnt vmcnt(4)
  s_add_u32 m0, s75, 16384
  s_mov_b32 s72, 65536
  buffer_load_dwordx4 v1, s[36:39], s72 offen nt lds
  s_waitcnt vmcnt(4)
  s_add_u32 m0, s75, 17408
  s_mov_b32 s72, 66560
  buffer_load_dwordx4 v1, s[36:39], s72 offen nt lds
  s_waitcnt vmcnt(4)
  s_add_u32 m0, s75, 18432
  s_mov_b32 s72, 67584
  buffer_load_dwordx4 v1, s[36:39], s72 offen nt lds
  s_waitcnt vmcnt(4)
  s_add_u32 m0, s75, 19456
  s_mov_b32 s72, 68608
  buffer_load_dwordx4 v1, s[36:39], s72 offen nt lds
  s_waitcnt vmcnt(4)
  s_add_u32 m0, s75, 20480
  s_mov_b32 s72, 81920
  buffer_load_dwordx4 v1, s[36:39], s72 offen nt lds
  s_waitcnt vmcnt(4)
  s_add_u32 m0, s75, 21504
  s_mov_b32 s72, 82944
  buffer_load_dwordx4 v1, s[36:39], s72 offen nt lds
  s_waitcnt vmcnt(4)
  s_add_u32 m0, s75, 22528
  s_mov_b32 s72, 83968
  buffer_load_dwordx4 v1, s[36:39], s72 offen nt lds
  s_waitcnt vmcnt(4)
  s_add_u32 m0, s75, 23552
  s_mov_b32 s72, 84992
  buffer_load_dwordx4 v1, s[36:39], s72 offen nt lds
  s_waitcnt vmcnt(4)
  s_add_u32 m0, s75, 24576
  s_mov_b32 s72, 98304
  buffer_load_dwordx4 v1, s[36:39], s72 offen nt lds
  s_waitcnt vmcnt(4)
  s_add_u32 m0, s75, 25600
  s_mov_b32 s72, 99328
  buffer_load_dwordx4 v1, s[36:39], s72 offen nt lds
  s_waitcnt vmcnt(4)
  s_add_u32 m0, s75, 26624
  s_mov_b32 s72, 100352
  buffer_load_dwordx4 v1, s[36:39], s72 offen nt lds
  s_waitcnt vmcnt(4)
  s_add_u32 m0, s75, 27648
  s_mov_b32 s72, 101376
  buffer_load_dwordx4 v1, s[36:39], s72 offen nt lds
  s_waitcnt vmcnt(4)
  s_add_u32 m0, s75, 28672
  s_mov_b32 s72, 114688
  buffer_load_dwordx4 v1, s[36:39], s72 offen nt lds
  s_waitcnt vmcnt(4)
  s_add_u32 m0, s75, 29696
  s_mov_b32 s72, 115712
  buffer_load_dwordx4 v1, s[36:39], s72 offen nt lds
  s_waitcnt vmcnt(4)
  s_add_u32 m0, s75, 30720
  s_mov_b32 s72, 116736
  buffer_load_dwordx4 v1, s[36:39], s72 offen nt lds
  s_waitcnt vmcnt(4)
  s_add_u32 m0, s75, 31744
  s_mov_b32 s72, 117760
  buffer_load_dwordx4 v1, s[36:39], s72 offen nt lds
  s_waitcnt vmcnt(4)
  s_mov_b32 s72, 131072
  buffer_load_dwordx4 v[64:67], v1, s[36:39], s72 offen offset:0 nt
  s_waitcnt vmcnt(4)
  buffer_load_dwordx4 v[68:71], v1, s[36:39], s72 offen offset:1024 nt
  s_waitcnt vmcnt(4)
  buffer_load_dwordx4 v[72:75], v1, s[36:39], s72 offen offset:2048 nt
  s_waitcnt vmcnt(4)
  buffer_load_dwordx4 v[76:79], v1, s[36:39], s72 offen offset:3072 nt
  s_waitcnt vmcnt(4)
  s_mov_b32 s72, 147456
  buffer_load_dwordx4 v[80:83], v1, s[36:39], s72 offen offset:0 nt
  s_waitcnt vmcnt(4)
  buffer_load_dwordx4 v[84:87], v1, s[36:39], s72 offen offset:1024 nt
  s_waitcnt vmcnt(4)
  buffer_load_dwordx4 v[88:91], v1, s[36:39], s72 offen offset:2048 nt
  s_waitcnt vmcnt(4)
  buffer_load_dwordx4 v[92:95], v1, s[36:39], s72 offen offset:3072 nt
  s_waitcnt vmcnt(4)
  s_mov_b32 s72, 163840
  buffer_load_dwordx4 v[96:99], v1, s[36:39], s72 offen offset:0 nt
  s_waitcnt vmcnt(4)
  buffer_load_dwordx4 v[100:103], v1, s[36:39], s72 offen offset:1024 nt
  s_waitcnt vmcnt(4)
  buffer_load_dwordx4 v[104:107], v1, s[36:39], s72 offen offset:2048 nt
  s_waitcnt vmcnt(4)
  buffer_load_dwordx4 v[108:111], v1, s[36:39], s72 offen offset:3072 nt
  s_waitcnt vmcnt(4)
  s_mov_b32 s72, 180224
  buffer_load_dwordx4 v[112:115], v1, s[36:39], s72 offen offset:0 nt
  s_waitcnt vmcnt(4)
  buffer_load_dwordx4 v[116:119], v1, s[36:39], s72 offen offset:1024 nt
  s_waitcnt vmcnt(4)
  buffer_load_dwordx4 v[120:123], v1, s[36:39], s72 offen offset:2048 nt
  s_waitcnt vmcnt(4)
  buffer_load_dwordx4 v[124:127], v1, s[36:39], s72 offen offset:3072 nt
  s_waitcnt vmcnt(4)
  s_mov_b32 s72, 196608
  buffer_load_dwordx4 v[128:131], v1, s[36:39], s72 offen offset:0 nt
  s_waitcnt vmcnt(4)
  buffer_load_dwordx4 v[132:135], v1, s[36:39], s72 offen offset:1024 nt
  s_waitcnt vmcnt(4)
  buffer_load_dwordx4 v[136:139], v1, s[36:39], s72 offen offset:2048 nt
  s_waitcnt vmcnt(4)
  buffer_load_dwordx4 v[140:143], v1, s[36:39], s72 offen offset:3072 nt
  s_waitcnt vmcnt(4)
  s_mov_b32 s72, 212992
  buffer_load_dwordx4 v[144:147], v1, s[36:39], s72 offen offset:0 nt
  s_waitcnt vmcnt(4)
  buffer_load_dwordx4 v[148:151], v1, s[36:39], s72 offen offset:1024 nt
  s_waitcnt vmcnt(4)
  buffer_load_dwordx4 v[152:155], v1, s[36:39], s72 offen offset:2048 nt
  s_waitcnt vmcnt(4)
  buffer_load_dwordx4 v[156:159], v1, s[36:39], s72 offen offset:3072 nt
  s_waitcnt vmcnt(4)
  s_mov_b32 s72, 229376
  buffer_load_dwordx4 v[160:163], v1, s[36:39], s72 offen offset:0 nt
  s_waitcnt vmcnt(4)
  buffer_load_dwordx4 v[164:167], v1, s[36:39], s72 offen offset:1024 nt
  s_waitcnt vmcnt(4)
  buffer_load_dwordx4 v[168:171], v1, s[36:39], s72 offen offset:2048 nt
  s_waitcnt vmcnt(4)
  buffer_load_dwordx4 v[172:175], v1, s[36:39], s72 offen offset:3072 nt
  s_waitcnt vmcnt(4)
  s_mov_b32 s72, 245760
  buffer_load_dwordx4 v[176:179], v1, s[36:39], s72 offen offset:0 nt
  s_waitcnt vmcnt(4)
  buffer_load_dwordx4 v[180:183], v1, s[36:39], s72 offen offset:1024 nt
  s_waitcnt vmcnt(4)
  buffer_load_dwordx4 v[184:187], v1, s[36:39], s72 offen offset:2048 nt
  s_waitcnt vmcnt(4)
  buffer_load_dwordx4 v[188:191], v1, s[36:39], s72 offen offset:3072 nt
  s_waitcnt vmcnt(4)
  s_mov_b32 s72, 0
  buffer_load_dwordx4 v[192:195], v1, s[40:43], s72 offen offset:0 nt
  s_waitcnt vmcnt(4)
  buffer_load_dwordx4 v[196:199], v1, s[40:43], s72 offen offset:1024 nt
  s_waitcnt vmcnt(4)
  buffer_load_dwordx4 v[200:203], v1, s[40:43], s72 offen offset:2048 nt
  s_waitcnt vmcnt(4)
  buffer_load_dwordx4 v[204:207], v1, s[40:43], s72 offen offset:3072 nt
  s_waitcnt vmcnt(4)
  s_mov_b32 s72, 16384
  buffer_load_dwordx4 v[208:211], v1, s[40:43], s72 offen offset:0 nt
  s_waitcnt vmcnt(4)
  buffer_load_dwordx4 v[212:215], v1, s[40:43], s72 offen offset:1024 nt
  s_waitcnt vmcnt(4)
  buffer_load_dwordx4 v[216:219], v1, s[40:43], s72 offen offset:2048 nt
  s_waitcnt vmcnt(4)
  buffer_load_dwordx4 v[220:223], v1, s[40:43], s72 offen offset:3072 nt
  s_waitcnt vmcnt(4)
  s_mov_b32 s72, 32768
  buffer_load_dwordx4 v[224:227], v1, s[40:43], s72 offen offset:0 nt
  s_waitcnt vmcnt(4)
  buffer_load_dwordx4 v[228:231], v1, s[40:43], s72 offen offset:1024 nt
  s_waitcnt vmcnt(4)
  buffer_load_dwordx4 v[232:235], v1, s[40:43], s72 offen offset:2048 nt
  s_waitcnt vmcnt(4)
  buffer_load_dwordx4 v[236:239], v1, s[40:43], s72 offen offset:3072 nt
  s_waitcnt vmcnt(4)
  v_mov_b32 v6, 0
  v_mov_b32 v7, 0
  v_mov_b32 v8, 0
  v_mov_b32 v9, 0
  v_mov_b32 v10, 0
  v_mov_b32 v11, 0
  v_mov_b32 v12, 0
  v_mov_b32 v13, 0
  v_add_u32 v27, s75, v1
  v_mov_b32 v14, 0
  s_mov_b32 s79, 0x400000
L_spin1:
  ds_read_b32 v15, v14 offset:12552
  s_waitcnt lgkmcnt(0)
  v_readfirstlane_b32 s4, v15
  s_cmp_ge_u32 s4, 1
  s_cbranch_scc1 L_spun2
  s_sub_u32 s79, s79, 1
  s_cmp_eq_u32 s79, 0
  s_cbranch_scc1 L_spun2
  s_sleep 2
  s_branch L_spin1
L_spun2:
  v_and_b32 v14, 15, v0
  v_lshlrev_b32 v14, 4, v14
  ds_read_b128 v[2:5], v14 offset:13312
  s_waitcnt lgkmcnt(0)
  v_mov_b32 v24, 0xff800000
  s_waitcnt vmcnt(40)
  v_dot2_f32_bf16 v14, v64, v2, 0
  v_dot2_f32_bf16 v15, v68, v2, 0
  v_dot2_f32_bf16 v16, v72, v2, 0
  v_dot2_f32_bf16 v17, v76, v2, 0
  v_dot2c_f32_bf16 v14, v65, v3
  v_dot2c_f32_bf16 v15, v69, v3
  v_dot2c_f32_bf16 v16, v73, v3
  v_dot2c_f32_bf16 v17, v77, v3
  v_dot2c_f32_bf16 v14, v66, v4
  v_dot2c_f32_bf16 v15, v70, v4
  v_dot2c_f32_bf16 v16, v74, v4
  v_dot2c_f32_bf16 v17, v78, v4
  v_dot2c_f32_bf16 v14, v67, v5
  v_dot2c_f32_bf16 v15, v71, v5
  v_dot2c_f32_bf16 v16, v75, v5
  v_dot2c_f32_bf16 v17, v79, v5
  v_add_f32_dpp v14, v14, v14 row_ror:8 row_mask:0xf bank_mask:0xf
  v_add_f32_dpp v15, v15, v15 row_ror:8 row_mask:0xf bank_mask:0xf
  v_add_f32_dpp v16, v16, v16 row_ror:8 row_mask:0xf bank_mask:0xf
  v_add_f32_dpp v17, v17, v17 row_ror:8 row_mask:0xf bank_mask:0xf
  v_add_f32_dpp v14, v14, v14 row_ror:4 row_mask:0xf bank_mask:0xf
  v_add_f32_dpp v15, v15, v15 row_ror:4 row_mask:0xf bank_mask:0xf
  v_add_f32_dpp v16, v16, v16 row_ror:4 row_mask:0xf bank_mask:0xf
  v_add_f32_dpp v17, v17, v17 row_ror:4 row_mask:0xf bank_mask:0xf
  v_add_f32_dpp v14, v14, v14 row_ror:2 row_mask:0xf bank_mask:0xf
  v_add_f32_dpp v15, v15, v15 row_ror:2 row_mask:0xf bank_mask:0xf
  v_add_f32_dpp v16, v16, v16 row_ror:2 row_mask:0xf bank_mask:0xf
  v_add_f32_dpp v17, v17, v17 row_ror:2 row_mask:0xf bank_mask:0xf
  v_add_f32_dpp v14, v14, v14 row_ror:1 row_mask:0xf bank_mask:0xf
  v_add_f32_dpp v15, v15, v15 row_ror:1 row_mask:0xf bank_mask:0xf
  v_add_f32_dpp v16, v16, v16 row_ror:1 row_mask:0xf bank_mask:0xf
  v_add_f32_dpp v17, v17, v17 row_ror:1 row_mask:0xf bank_mask:0xf
  v_cvt_pk_bf16_f32 v20, v14, v15
  v_cvt_pk_bf16_f32 v23, v16, v17
  v_lshlrev_b32 v18, 16, v20
  v_and_b32 v19, s78, v20
  v_lshlrev_b32 v21, 16, v23
  v_and_b32 v22, s78, v23
  v_mul_f32 v18, s76, v18
  v_mul_f32 v19, s76, v19
  v_mul_f32 v21, s76, v21
  v_mul_f32 v22, s76, v22
  v_max3_f32 v24, v18, v19, v24
  v_cvt_pk_bf16_f32 v48, v18, v19
  v_max3_f32 v24, v21, v22, v24
  v_cvt_pk_bf16_f32 v49, v21, v22
  s_mov_b32 s72, 49152
  buffer_load_dwordx4 v[64:67], v1, s[40:43], s72 offen offset:0 nt
  s_waitcnt vmcnt(37)
  v_dot2_f32_bf16 v14, v80, v2, 0
  v_dot2_f32_bf16 v15, v84, v2, 0
  v_dot2_f32_bf16 v16, v88, v2, 0
  v_dot2_f32_bf16 v17, v92, v2, 0
  v_dot2c_f32_bf16 v14, v81, v3
  v_dot2c_f32_bf16 v15, v85, v3
  v_dot2c_f32_bf16 v16, v89, v3
  v_dot2c_f32_bf16 v17, v93, v3
  v_dot2c_f32_bf16 v14, v82, v4
  v_dot2c_f32_bf16 v15, v86, v4
  v_dot2c_f32_bf16 v16, v90, v4
  v_dot2c_f32_bf16 v17, v94, v4
  v_dot2c_f32_bf16 v14, v83, v5
  v_dot2c_f32_bf16 v15, v87, v5
  v_dot2c_f32_bf16 v16, v91, v5
  v_dot2c_f32_bf16 v17, v95, v5
  v_add_f32_dpp v14, v14, v14 row_ror:8 row_mask:0xf bank_mask:0xf
  v_add_f32_dpp v15, v15, v15 row_ror:8 row_mask:0xf bank_mask:0xf
  v_add_f32_dpp v16, v16, v16 row_ror:8 row_mask:0xf bank_mask:0xf
  v_add_f32_dpp v17, v17, v17 row_ror:8 row_mask:0xf bank_mask:0xf
  v_add_f32_dpp v14, v14, v14 row_ror:4 row_mask:0xf bank_mask:0xf
  v_add_f32_dpp v15, v15, v15 row_ror:4 row_mask:0xf bank_mask:0xf
  v_add_f32_dpp v16, v16, v16 row_ror:4 row_mask:0xf bank_mask:0xf
  v_add_f32_dpp v17, v17, v17 row_ror:4 row_mask:0xf bank_mask:0xf
  v_add_f32_dpp v14, v14, v14 row_ror:2 row_mask:0xf bank_mask:0xf
  v_add_f32_dpp v15, v15, v15 row_ror:2 row_mask:0xf bank_mask:0xf
  v_add_f32_dpp v16, v16, v16 row_ror:2 row_mask:0xf bank_mask:0xf
  v_add_f32_dpp v17, v17, v17 row_ror:2 row_mask:0xf bank_mask:0xf
  v_add_f32_dpp v14, v14, v14 row_ror:1 row_mask:0xf bank_mask:0xf
  v_add_f32_dpp v15, v15, v15 row_ror:1 row_mask:0xf bank_mask:0xf
  v_add_f32_dpp v16, v16, v16 row_ror:1 row_mask:0xf bank_mask:0xf
  v_add_f32_dpp v17, v17, v17 row_ror:1 row_mask:0xf bank_mask:0xf
  v_cvt_pk_bf16_f32 v20, v14, v15
  v_cvt_pk_bf16_f32 v23, v16, v17
  v_lshlrev_b32 v18, 16, v20
  v_and_b32 v19, s78, v20
  v_lshlrev_b32 v21, 16, v23
  v_and_b32 v22, s78, v23
  v_mul_f32 v18, s76, v18
  v_mul_f32 v19, s76, v19
  v_mul_f32 v21, s76, v21
  v_mul_f32 v22, s76, v22
  v_max3_f32 v24, v18, v19, v24
  v_cvt_pk_bf16_f32 v50, v18, v19
  v_max3_f32 v24, v21, v22, v24
  v_cvt_pk_bf16_f32 v51, v21, v22
  buffer_load_dwordx4 v[68:71], v1, s[40:43], s72 offen offset:1024 nt
  s_waitcnt vmcnt(34)
  v_dot2_f32_bf16 v14, v96, v2, 0
  v_dot2_f32_bf16 v15, v100, v2, 0
  v_dot2_f32_bf16 v16, v104, v2, 0
  v_dot2_f32_bf16 v17, v108, v2, 0
  v_dot2c_f32_bf16 v14, v97, v3
  v_dot2c_f32_bf16 v15, v101, v3
  v_dot2c_f32_bf16 v16, v105, v3
  v_dot2c_f32_bf16 v17, v109, v3
  v_dot2c_f32_bf16 v14, v98, v4
  v_dot2c_f32_bf16 v15, v102, v4
  v_dot2c_f32_bf16 v16, v106, v4
  v_dot2c_f32_bf16 v17, v110, v4
  v_dot2c_f32_bf16 v14, v99, v5
  v_dot2c_f32_bf16 v15, v103, v5
  v_dot2c_f32_bf16 v16, v107, v5
  v_dot2c_f32_bf16 v17, v111, v5
  v_add_f32_dpp v14, v14, v14 row_ror:8 row_mask:0xf bank_mask:0xf
  v_add_f32_dpp v15, v15, v15 row_ror:8 row_mask:0xf bank_mask:0xf
  v_add_f32_dpp v16, v16, v16 row_ror:8 row_mask:0xf bank_mask:0xf
  v_add_f32_dpp v17, v17, v17 row_ror:8 row_mask:0xf bank_mask:0xf
  v_add_f32_dpp v14, v14, v14 row_ror:4 row_mask:0xf bank_mask:0xf
  v_add_f32_dpp v15, v15, v15 row_ror:4 row_mask:0xf bank_mask:0xf
  v_add_f32_dpp v16, v16, v16 row_ror:4 row_mask:0xf bank_mask:0xf
  v_add_f32_dpp v17, v17, v17 row_ror:4 row_mask:0xf bank_mask:0xf
  v_add_f32_dpp v14, v14, v14 row_ror:2 row_mask:0xf bank_mask:0xf
  v_add_f32_dpp v15, v15, v15 row_ror:2 row_mask:0xf bank_mask:0xf
  v_add_f32_dpp v16, v16, v16 row_ror:2 row_mask:0xf bank_mask:0xf
  v_add_f32_dpp v17, v17, v17 row_ror:2 row_mask:0xf bank_mask:0xf
  v_add_f32_dpp v14, v14, v14 row_ror:1 row_mask:0xf bank_mask:0xf
  v_add_f32_dpp v15, v15, v15 row_ror:1 row_mask:0xf bank_mask:0xf
  v_add_f32_dpp v16, v16, v16 row_ror:1 row_mask:0xf bank_mask:0xf
  v_add_f32_dpp v17, v17, v17 row_ror:1 row_mask:0xf bank_mask:0xf
  v_cvt_pk_bf16_f32 v20, v14, v15
  v_cvt_pk_bf16_f32 v23, v16, v17
  v_lshlrev_b32 v18, 16, v20
  v_and_b32 v19, s78, v20
  v_lshlrev_b32 v21, 16, v23
  v_and_b32 v22, s78, v23
  v_mul_f32 v18, s76, v18
  v_mul_f32 v19, s76, v19
  v_mul_f32 v21, s76, v21
  v_mul_f32 v22, s76, v22
  v_max3_f32 v24, v18, v19, v24
  v_cvt_pk_bf16_f32 v52, v18, v19
  v_max3_f32 v24, v21, v22, v24
  v_cvt_pk_bf16_f32 v53, v21, v22
  buffer_load_dwordx4 v[72:75], v1, s[40:43], s72 offen offset:2048 nt
  s_waitcnt vmcnt(31)
  v_dot2_f32_bf16 v14, v112, v2, 0
  v_dot2_f32_bf16 v15, v116, v2, 0
  v_dot2_f32_bf16 v16, v120, v2, 0
  v_dot2_f32_bf16 v17, v124, v2, 0
  v_dot2c_f32_bf16 v14, v113, v3
  v_dot2c_f32_bf16 v15, v117, v3
  v_dot2c_f32_bf16 v16, v121, v3
  v_dot2c_f32_bf16 v17, v125, v3
  v_dot2c_f32_bf16 v14, v114, v4
  v_dot2c_f32_bf16 v15, v118, v4
  v_dot2c_f32_bf16 v16, v122, v4
  v_dot2c_f32_bf16 v17, v126, v4
  v_dot2c_f32_bf16 v14, v115, v5
  v_dot2c_f32_bf16 v15, v119, v5
  v_dot2c_f32_bf16 v16, v123, v5
  v_dot2c_f32_bf16 v17, v127, v5
  v_add_f32_dpp v14, v14, v14 row_ror:8 row_mask:0xf bank_mask:0xf
  v_add_f32_dpp v15, v15, v15 row_ror:8 row_mask:0xf bank_mask:0xf
  v_add_f32_dpp v16, v16, v16 row_ror:8 row_mask:0xf bank_mask:0xf
  v_add_f32_dpp v17, v17, v17 row_ror:8 row_mask:0xf bank_mask:0xf
  v_add_f32_dpp v14, v14, v14 row_ror:4 row_mask:0xf bank_mask:0xf
  v_add_f32_dpp v15, v15, v15 row_ror:4 row_mask:0xf bank_mask:0xf
  v_add_f32_dpp v16, v16, v16 row_ror:4 row_mask:0xf bank_mask:0xf
  v_add_f32_dpp v17, v17, v17 row_ror:4 row_mask:0xf bank_mask:0xf
  v_add_f32_dpp v14, v14, v14 row_ror:2 row_mask:0xf bank_mask:0xf
  v_add_f32_dpp v15, v15, v15 row_ror:2 row_mask:0xf bank_mask:0xf
  v_add_f32_dpp v16, v16, v16 row_ror:2 row_mask:0xf bank_mask:0xf
  v_add_f32_dpp v17, v17, v17 row_ror:2 row_mask:0xf bank_mask:0xf
  v_add_f32_dpp v14, v14, v14 row_ror:1 row_mask:0xf bank_mask:0xf
  v_add_f32_dpp v15, v15, v15 row_ror:1 row_mask:0xf bank_mask:0xf
  v_add_f32_dpp v16, v16, v16 row_ror:1 row_mask:0xf bank_mask:0xf
  v_add_f32_dpp v17, v17, v17 row_ror:1 row_mask:0xf bank_mask:0xf
  v_cvt_pk_bf16_f32 v20, v14, v15
  v_cvt_pk_bf16_f32 v23, v16, v17
  v_lshlrev_b32 v18, 16, v20
  v_and_b32 v19, s78, v20
  v_lshlrev_b32 v21, 16, v23
  v_and_b32 v22, s78, v23
  v_mul_f32 v18, s76, v18
  v_mul_f32 v19, s76, v19
  v_mul_f32 v21, s76, v21
  v_mul_f32 v22, s76, v22
  v_max3_f32 v24, v18, v19, v24
  v_cvt_pk_bf16_f32 v54, v18, v19
  v_max3_f32 v24, v21, v22, v24
  v_cvt_pk_bf16_f32 v55, v21, v22
  buffer_load_dwordx4 v[76:79], v1, s[40:43], s72 offen offset:3072 nt
  s_waitcnt vmcnt(28)
  v_dot2_f32_bf16 v14, v128, v2, 0
  v_dot2_f32_bf16 v15, v132, v2, 0
  v_dot2_f32_bf16 v16, v136, v2, 0
  v_dot2_f32_bf16 v17, v140, v2, 0
  v_dot2c_f32_bf16 v14, v129, v3
  v_dot2c_f32_bf16 v15, v133, v3
  v_dot2c_f32_bf16 v16, v137, v3
  v_dot2c_f32_bf16 v17, v141, v3
  v_dot2c_f32_bf16 v14, v130, v4
  v_dot2c_f32_bf16 v15, v134, v4
  v_dot2c_f32_bf16 v16, v138, v4
  v_dot2c_f32_bf16 v17, v142, v4
  v_dot2c_f32_bf16 v14, v131, v5
  v_dot2c_f32_bf16 v15, v135, v5
  v_dot2c_f32_bf16 v16, v139, v5
  v_dot2c_f32_bf16 v17, v143, v5
  v_add_f32_dpp v14, v14, v14 row_ror:8 row_mask:0xf bank_mask:0xf
  v_add_f32_dpp v15, v15, v15 row_ror:8 row_mask:0xf bank_mask:0xf
  v_add_f32_dpp v16, v16, v16 row_ror:8 row_mask:0xf bank_mask:0xf
  v_add_f32_dpp v17, v17, v17 row_ror:8 row_mask:0xf bank_mask:0xf
  v_add_f32_dpp v14, v14, v14 row_ror:4 row_mask:0xf bank_mask:0xf
  v_add_f32_dpp v15, v15, v15 row_ror:4 row_mask:0xf bank_mask:0xf
  v_add_f32_dpp v16, v16, v16 row_ror:4 row_mask:0xf bank_mask:0xf
  v_add_f32_dpp v17, v17, v17 row_ror:4 row_mask:0xf bank_mask:0xf
  v_add_f32_dpp v14, v14, v14 row_ror:2 row_mask:0xf bank_mask:0xf
  v_add_f32_dpp v15, v15, v15 row_ror:2 row_mask:0xf bank_mask:0xf
  v_add_f32_dpp v16, v16, v16 row_ror:2 row_mask:0xf bank_mask:0xf
  v_add_f32_dpp v17, v17, v17 row_ror:2 row_mask:0xf bank_mask:0xf
  v_add_f32_dpp v14, v14, v14 row_ror:1 row_mask:0xf bank_mask:0xf
  v_add_f32_dpp v15, v15, v15 row_ror:1 row_mask:0xf bank_mask:0xf
  v_add_f32_dpp v16, v16, v16 row_ror:1 row_mask:0xf bank_mask:0xf
  v_add_f32_dpp v17, v17, v17 row_ror:1 row_mask:0xf bank_mask:0xf
  v_cvt_pk_bf16_f32 v20, v14, v15
  v_cvt_pk_bf16_f32 v23, v16, v17
  v_lshlrev_b32 v18, 16, v20
  v_and_b32 v19, s78, v20
  v_lshlrev_b32 v21, 16, v23
  v_and_b32 v22, s78, v23
  v_mul_f32 v18, s76, v18
  v_mul_f32 v19, s76, v19
  v_mul_f32 v21, s76, v21
  v_mul_f32 v22, s76, v22
  v_max3_f32 v24, v18, v19, v24
  v_cvt_pk_bf16_f32 v56, v18, v19
  v_max3_f32 v24, v21, v22, v24
  v_cvt_pk_bf16_f32 v57, v21, v22
  s_mov_b32 s72, 65536
  buffer_load_dwordx4 v[80:83], v1, s[40:43], s72 offen offset:0 nt
  s_waitcnt vmcnt(25)
  v_dot2_f32_bf16 v14, v144, v2, 0
  v_dot2_f32_bf16 v15, v148, v2, 0
  v_dot2_f32_bf16 v16, v152, v2, 0
  v_dot2_f32_bf16 v17, v156, v2, 0
  v_dot2c_f32_bf16 v14, v145, v3
  v_dot2c_f32_bf16 v15, v149, v3
  v_dot2c_f32_bf16 v16, v153, v3
  v_dot2c_f32_bf16 v17, v157, v3
  v_dot2c_f32_bf16 v14, v146, v4
  v_dot2c_f32_bf16 v15, v150, v4
  v_dot2c_f32_bf16 v16, v154, v4
  v_dot2c_f32_bf16 v17, v158, v4
  v_dot2c_f32_bf16 v14, v147, v5
  v_dot2c_f32_bf16 v15, v151, v5
  v_dot2c_f32_bf16 v16, v155, v5
  v_dot2c_f32_bf16 v17, v159, v5
  v_add_f32_dpp v14, v14, v14 row_ror:8 row_mask:0xf bank_mask:0xf
  v_add_f32_dpp v15, v15, v15 row_ror:8 row_mask:0xf bank_mask:0xf
  v_add_f32_dpp v16, v16, v16 row_ror:8 row_mask:0xf bank_mask:0xf
  v_add_f32_dpp v17, v17, v17 row_ror:8 row_mask:0xf bank_mask:0xf
  v_add_f32_dpp v14, v14, v14 row_ror:4 row_mask:0xf bank_mask:0xf
  v_add_f32_dpp v15, v15, v15 row_ror:4 row_mask:0xf bank_mask:0xf
  v_add_f32_dpp v16, v16, v16 row_ror:4 row_mask:0xf bank_mask:0xf
  v_add_f32_dpp v17, v17, v17 row_ror:4 row_mask:0xf bank_mask:0xf
  v_add_f32_dpp v14, v14, v14 row_ror:2 row_mask:0xf bank_mask:0xf
  v_add_f32_dpp v15, v15, v15 row_ror:2 row_mask:0xf bank_mask:0xf
  v_add_f32_dpp v16, v16, v16 row_ror:2 row_mask:0xf bank_mask:0xf
  v_add_f32_dpp v17, v17, v17 row_ror:2 row_mask:0xf bank_mask:0xf
  v_add_f32_dpp v14, v14, v14 row_ror:1 row_mask:0xf bank_mask:0xf
  v_add_f32_dpp v15, v15, v15 row_ror:1 row_mask:0xf bank_mask:0xf
  v_add_f32_dpp v16, v16, v16 row_ror:1 row_mask:0xf bank_mask:0xf
  v_add_f32_dpp v17, v17, v17 row_ror:1 row_mask:0xf bank_mask:0xf
  v_cvt_pk_bf16_f32 v20, v14, v15
  v_cvt_pk_bf16_f32 v23, v16, v17
  v_lshlrev_b32 v18, 16, v20
  v_and_b32 v19, s78, v20
  v_lshlrev_b32 v21, 16, v23
  v_and_b32 v22, s78, v23
  v_mul_f32 v18, s76, v18
  v_mul_f32 v19, s76, v19
  v_mul_f32 v21, s76, v21
  v_mul_f32 v22, s76, v22
  v_max3_f32 v24, v18, v19, v24
  v_cvt_pk_bf16_f32 v58, v18, v19
  v_max3_f32 v24, v21, v22, v24
  v_cvt_pk_bf16_f32 v59, v21, v22
  buffer_load_dwordx4 v[84:87], v1, s[40:43], s72 offen offset:1024 nt
  s_waitcnt vmcnt(22)
  v_dot2_f32_bf16 v14, v160, v2, 0
  v_dot2_f32_bf16 v15, v164, v2, 0
  v_dot2_f32_bf16 v16, v168, v2, 0
  v_dot2_f32_bf16 v17, v172, v2, 0
  v_dot2c_f32_bf16 v14, v161, v3
  v_dot2c_f32_bf16 v15, v165, v3
  v_dot2c_f32_bf16 v16, v169, v3
  v_dot2c_f32_bf16 v17, v173, v3
  v_dot2c_f32_bf16 v14, v162, v4
  v_dot2c_f32_bf16 v15, v166, v4
  v_dot2c_f32_bf16 v16, v170, v4
  v_dot2c_f32_bf16 v17, v174, v4
  v_dot2c_f32_bf16 v14, v163, v5
  v_dot2c_f32_bf16 v15, v167, v5
  v_dot2c_f32_bf16 v16, v171, v5
  v_dot2c_f32_bf16 v17, v175, v5
  v_add_f32_dpp v14, v14, v14 row_ror:8 row_mask:0xf bank_mask:0xf
  v_add_f32_dpp v15, v15, v15 row_ror:8 row_mask:0xf bank_mask:0xf
  v_add_f32_dpp v16, v16, v16 row_ror:8 row_mask:0xf bank_mask:0xf
  v_add_f32_dpp v17, v17, v17 row_ror:8 row_mask:0xf bank_mask:0xf
  v_add_f32_dpp v14, v14, v14 row_ror:4 row_mask:0xf bank_mask:0xf
  v_add_f32_dpp v15, v15, v15 row_ror:4 row_mask:0xf bank_mask:0xf
  v_add_f32_dpp v16, v16, v16 row_ror:4 row_mask:0xf bank_mask:0xf
  v_add_f32_dpp v17, v17, v17 row_ror:4 row_mask:0xf bank_mask:0xf
  v_add_f32_dpp v14, v14, v14 row_ror:2 row_mask:0xf bank_mask:0xf
  v_add_f32_dpp v15, v15, v15 row_ror:2 row_mask:0xf bank_mask:0xf
  v_add_f32_dpp v16, v16, v16 row_ror:2 row_mask:0xf bank_mask:0xf
  v_add_f32_dpp v17, v17, v17 row_ror:2 row_mask:0xf bank_mask:0xf
  v_add_f32_dpp v14, v14, v14 row_ror:1 row_mask:0xf bank_mask:0xf
  v_add_f32_dpp v15, v15, v15 row_ror:1 row_mask:0xf bank_mask:0xf
  v_add_f32_dpp v16, v16, v16 row_ror:1 row_mask:0xf bank_mask:0xf
  v_add_f32_dpp v17, v17, v17 row_ror:1 row_mask:0xf bank_mask:0xf
  v_cvt_pk_bf16_f32 v20, v14, v15
  v_cvt_pk_bf16_f32 v23, v16, v17
  v_lshlrev_b32 v18, 16, v20
  v_and_b32 v19, s78, v20
  v_lshlrev_b32 v21, 16, v23
  v_and_b32 v22, s78, v23
  v_mul_f32 v18, s76, v18
  v_mul_f32 v19, s76, v19
  v_mul_f32 v21, s76, v21
  v_mul_f32 v22, s76, v22
  v_max3_f32 v24, v18, v19, v24
  v_cvt_pk_bf16_f32 v60, v18, v19
  v_max3_f32 v24, v21, v22, v24
  v_cvt_pk_bf16_f32 v61, v21, v22
  buffer_load_dwordx4 v[88:91], v1, s[40:43], s72 offen offset:2048 nt
  s_waitcnt vmcnt(19)
  v_dot2_f32_bf16 v14, v176, v2, 0
  v_dot2_f32_bf16 v15, v180, v2, 0
  v_dot2_f32_bf16 v16, v184, v2, 0
  v_dot2_f32_bf16 v17, v188, v2, 0
  v_dot2c_f32_bf16 v14, v177, v3
  v_dot2c_f32_bf16 v15, v181, v3
  v_dot2c_f32_bf16 v16, v185, v3
  v_dot2c_f32_bf16 v17, v189, v3
  v_dot2c_f32_bf16 v14, v178, v4
  v_dot2c_f32_bf16 v15, v182, v4
  v_dot2c_f32_bf16 v16, v186, v4
  v_dot2c_f32_bf16 v17, v190, v4
  v_dot2c_f32_bf16 v14, v179, v5
  v_dot2c_f32_bf16 v15, v183, v5
  v_dot2c_f32_bf16 v16, v187, v5
  v_dot2c_f32_bf16 v17, v191, v5
  s_waitcnt vmcnt(63)
  ds_read_b128 v[240:243], v27 offset:0
  ds_read_b128 v[244:247], v27 offset:1024
  ds_read_b128 v[248:251], v27 offset:2048
  ds_read_b128 v[252:255], v27 offset:3072
  v_add_f32_dpp v14, v14, v14 row_ror:8 row_mask:0xf bank_mask:0xf
  v_add_f32_dpp v15, v15, v15 row_ror:8 row_mask:0xf bank_mask:0xf
  v_add_f32_dpp v16, v16, v16 row_ror:8 row_mask:0xf bank_mask:0xf
  v_add_f32_dpp v17, v17, v17 row_ror:8 row_mask:0xf bank_mask:0xf
  v_add_f32_dpp v14, v14, v14 row_ror:4 row_mask:0xf bank_mask:0xf
  v_add_f32_dpp v15, v15, v15 row_ror:4 row_mask:0xf bank_mask:0xf
  v_add_f32_dpp v16, v16, v16 row_ror:4 row_mask:0xf bank_mask:0xf
  v_add_f32_dpp v17, v17, v17 row_ror:4 row_mask:0xf bank_mask:0xf
  v_add_f32_dpp v14, v14, v14 row_ror:2 row_mask:0xf bank_mask:0xf
  v_add_f32_dpp v15, v15, v15 row_ror:2 row_mask:0xf bank_mask:0xf
  v_add_f32_dpp v16, v16, v16 row_ror:2 row_mask:0xf bank_mask:0xf
  v_add_f32_dpp v17, v17, v17 row_ror:2 row_mask:0xf bank_mask:0xf
  v_add_f32_dpp v14, v14, v14 row_ror:1 row_mask:0xf bank_mask:0xf
  v_add_f32_dpp v15, v15, v15 row_ror:1 row_mask:0xf bank_mask:0xf
  v_add_f32_dpp v16, v16, v16 row_ror:1 row_mask:0xf bank_mask:0xf
  v_add_f32_dpp v17, v17, v17 row_ror:1 row_mask:0xf bank_mask:0xf
  v_cvt_pk_bf16_f32 v20, v14, v15
  v_cvt_pk_bf16_f32 v23, v16, v17
  v_lshlrev_b32 v18, 16, v20
  v_and_b32 v19, s78, v20
  v_lshlrev_b32 v21, 16, v23
  v_and_b32 v22, s78, v23
  v_mul_f32 v18, s76, v18
  v_mul_f32 v19, s76, v19
  v_mul_f32 v21, s76, v21
  v_mul_f32 v22, s76, v22
  v_max3_f32 v24, v18, v19, v24
  v_cvt_pk_bf16_f32 v62, v18, v19
  v_max3_f32 v24, v21, v22, v24
  v_cvt_pk_bf16_f32 v63, v21, v22
  buffer_load_dwordx4 v[92:95], v1, s[40:43], s72 offen offset:3072 nt
  s_waitcnt lgkmcnt(0)
  v_dot2_f32_bf16 v14, v240, v2, 0
  v_dot2_f32_bf16 v15, v244, v2, 0
  v_dot2_f32_bf16 v16, v248, v2, 0
  v_dot2_f32_bf16 v17, v252, v2, 0
  v_dot2c_f32_bf16 v14, v241, v3
  v_dot2c_f32_bf16 v15, v245, v3
  v_dot2c_f32_bf16 v16, v249, v3
  v_dot2c_f32_bf16 v17, v253, v3
  v_dot2c_f32_bf16 v14, v242, v4
  v_dot2c_f32_bf16 v15, v246, v4
  v_dot2c_f32_bf16 v16, v250, v4
  v_dot2c_f32_bf16 v17, v254, v4
  v_dot2c_f32_bf16 v14, v243, v5
  v_dot2c_f32_bf16 v15, v247, v5
  v_dot2c_f32_bf16 v16, v251, v5
  v_dot2c_f32_bf16 v17, v255, v5
  s_waitcnt vmcnt(63)
  ds_read_b128 v[240:243], v27 offset:4096
  ds_read_b128 v[244:247], v27 offset:5120
  ds_read_b128 v[248:251], v27 offset:6144
  ds_read_b128 v[252:255], v27 offset:7168
  v_add_f32_dpp v14, v14, v14 row_ror:8 row_mask:0xf bank_mask:0xf
  v_add_f32_dpp v15, v15, v15 row_ror:8 row_mask:0xf bank_mask:0xf
  v_add_f32_dpp v16, v16, v16 row_ror:8 row_mask:0xf bank_mask:0xf
  v_add_f32_dpp v17, v17, v17 row_ror:8 row_mask:0xf bank_mask:0xf
  v_add_f32_dpp v14, v14, v14 row_ror:4 row_mask:0xf bank_mask:0xf
  v_add_f32_dpp v15, v15, v15 row_ror:4 row_mask:0xf bank_mask:0xf
  v_add_f32_dpp v16, v16, v16 row_ror:4 row_mask:0xf bank_mask:0xf
  v_add_f32_dpp v17, v17, v17 row_ror:4 row_mask:0xf bank_mask:0xf
  v_add_f32_dpp v14, v14, v14 row_ror:2 row_mask:0xf bank_mask:0xf
  v_add_f32_dpp v15, v15, v15 row_ror:2 row_mask:0xf bank_mask:0xf
  v_add_f32_dpp v16, v16, v16 row_ror:2 row_mask:0xf bank_mask:0xf
  v_add_f32_dpp v17, v17, v17 row_ror:2 row_mask:0xf bank_mask:0xf
  v_add_f32_dpp v14, v14, v14 row_ror:1 row_mask:0xf bank_mask:0xf
  v_add_f32_dpp v15, v15, v15 row_ror:1 row_mask:0xf bank_mask:0xf
  v_add_f32_dpp v16, v16, v16 row_ror:1 row_mask:0xf bank_mask:0xf
  v_add_f32_dpp v17, v17, v17 row_ror:1 row_mask:0xf bank_mask:0xf
  v_cvt_pk_bf16_f32 v20, v14, v15
  v_cvt_pk_bf16_f32 v23, v16, v17
  v_lshlrev_b32 v18, 16, v20
  v_and_b32 v19, s78, v20
  v_lshlrev_b32 v21, 16, v23
  v_and_b32 v22, s78, v23
  v_mul_f32 v18, s76, v18
  v_mul_f32 v19, s76, v19
  v_mul_f32 v21, s76, v21
  v_mul_f32 v22, s76, v22
  v_max3_f32 v24, v18, v19, v24
  v_cvt_pk_bf16_f32 v32, v18, v19
  v_max3_f32 v24, v21, v22, v24
  v_cvt_pk_bf16_f32 v33, v21, v22
  s_mov_b32 s72, 81920
  buffer_load_dwordx4 v[96:99], v1, s[40:43], s72 offen offset:0 nt
  s_waitcnt lgkmcnt(0)
  v_dot2_f32_bf16 v14, v240, v2, 0
  v_dot2_f32_bf16 v15, v244, v2, 0
  v_dot2_f32_bf16 v16, v248, v2, 0
  v_dot2_f32_bf16 v17, v252, v2, 0
  v_dot2c_f32_bf16 v14, v241, v3
  v_dot2c_f32_bf16 v15, v245, v3
  v_dot2c_f32_bf16 v16, v249, v3
  v_dot2c_f32_bf16 v17, v253, v3
  v_dot2c_f32_bf16 v14, v242, v4
  v_dot2c_f32_bf16 v15, v246, v4
  v_dot2c_f32_bf16 v16, v250, v4
  v_dot2c_f32_bf16 v17, v254, v4
  v_dot2c_f32_bf16 v14, v243, v5
  v_dot2c_f32_bf16 v15, v247, v5
  v_dot2c_f32_bf16 v16, v251, v5
  v_dot2c_f32_bf16 v17, v255, v5
  s_waitcnt vmcnt(63)
  ds_read_b128 v[240:243], v27 offset:8192
  ds_read_b128 v[244:247], v27 offset:9216
  ds_read_b128 v[248:251], v27 offset:10240
  ds_read_b128 v[252:255], v27 offset:11264
  v_add_f32_dpp v14, v14, v14 row_ror:8 row_mask:0xf bank_mask:0xf
  v_add_f32_dpp v15, v15, v15 row_ror:8 row_mask:0xf bank_mask:0xf
  v_add_f32_dpp v16, v16, v16 row_ror:8 row_mask:0xf bank_mask:0xf
  v_add_f32_dpp v17, v17, v17 row_ror:8 row_mask:0xf bank_mask:0xf
  v_add_f32_dpp v14, v14, v14 row_ror:4 row_mask:0xf bank_mask:0xf
  v_add_f32_dpp v15, v15, v15 row_ror:4 row_mask:0xf bank_mask:0xf
  v_add_f32_dpp v16, v16, v16 row_ror:4 row_mask:0xf bank_mask:0xf
  v_add_f32_dpp v17, v17, v17 row_ror:4 row_mask:0xf bank_mask:0xf
  v_add_f32_dpp v14, v14, v14 row_ror:2 row_mask:0xf bank_mask:0xf
  v_add_f32_dpp v15, v15, v15 row_ror:2 row_mask:0xf bank_mask:0xf
  v_add_f32_dpp v16, v16, v16 row_ror:2 row_mask:0xf bank_mask:0xf
  v_add_f32_dpp v17, v17, v17 row_ror:2 row_mask:0xf bank_mask:0xf
  v_add_f32_dpp v14, v14, v14 row_ror:1 row_mask:0xf bank_mask:0xf
  v_add_f32_dpp v15, v15, v15 row_ror:1 row_mask:0xf bank_mask:0xf
  v_add_f32_dpp v16, v16, v16 row_ror:1 row_mask:0xf bank_mask:0xf
  v_add_f32_dpp v17, v17, v17 row_ror:1 row_mask:0xf bank_mask:0xf
  v_cvt_pk_bf16_f32 v20, v14, v15
  v_cvt_pk_bf16_f32 v23, v16, v17
  v_lshlrev_b32 v18, 16, v20
  v_and_b32 v19, s78, v20
  v_lshlrev_b32 v21, 16, v23
  v_and_b32 v22, s78, v23
  v_mul_f32 v18, s76, v18
  v_mul_f32 v19, s76, v19
  v_mul_f32 v21, s76, v21
  v_mul_f32 v22, s76, v22
  v_max3_f32 v24, v18, v19, v24
  v_cvt_pk_bf16_f32 v34, v18, v19
  v_max3_f32 v24, v21, v22, v24
  v_cvt_pk_bf16_f32 v35, v21, v22
  buffer_load_dwordx4 v[100:103], v1, s[40:43], s72 offen offset:1024 nt
  s_waitcnt lgkmcnt(0)
  v_dot2_f32_bf16 v14, v240, v2, 0
  v_dot2_f32_bf16 v15, v244, v2, 0
  v_dot2_f32_bf16 v16, v248, v2, 0
  v_dot2_f32_bf16 v17, v252, v2, 0
  v_dot2c_f32_bf16 v14, v241, v3
  v_dot2c_f32_bf16 v15, v245, v3
  v_dot2c_f32_bf16 v16, v249, v3
  v_dot2c_f32_bf16 v17, v253, v3
  v_dot2c_f32_bf16 v14, v242, v4
  v_dot2c_f32_bf16 v15, v246, v4
  v_dot2c_f32_bf16 v16, v250, v4
  v_dot2c_f32_bf16 v17, v254, v4
  v_dot2c_f32_bf16 v14, v243, v5
  v_dot2c_f32_bf16 v15, v247, v5
  v_dot2c_f32_bf16 v16, v251, v5
  v_dot2c_f32_bf16 v17, v255, v5
  s_waitcnt vmcnt(63)
  ds_read_b128 v[240:243], v27 offset:12288
  ds_read_b128 v[244:247], v27 offset:13312
  ds_read_b128 v[248:251], v27 offset:14336
  ds_read_b128 v[252:255], v27 offset:15360
  v_add_f32_dpp v14, v14, v14 row_ror:8 row_mask:0xf bank_mask:0xf
  v_add_f32_dpp v15, v15, v15 row_ror:8 row_mask:0xf bank_mask:0xf
  v_add_f32_dpp v16, v16, v16 row_ror:8 row_mask:0xf bank_mask:0xf
  v_add_f32_dpp v17, v17, v17 row_ror:8 row_mask:0xf bank_mask:0xf
  v_add_f32_dpp v14, v14, v14 row_ror:4 row_mask:0xf bank_mask:0xf
  v_add_f32_dpp v15, v15, v15 row_ror:4 row_mask:0xf bank_mask:0xf
  v_add_f32_dpp v16, v16, v16 row_ror:4 row_mask:0xf bank_mask:0xf
  v_add_f32_dpp v17, v17, v17 row_ror:4 row_mask:0xf bank_mask:0xf
  v_add_f32_dpp v14, v14, v14 row_ror:2 row_mask:0xf bank_mask:0xf
  v_add_f32_dpp v15, v15, v15 row_ror:2 row_mask:0xf bank_mask:0xf
  v_add_f32_dpp v16, v16, v16 row_ror:2 row_mask:0xf bank_mask:0xf
  v_add_f32_dpp v17, v17, v17 row_ror:2 row_mask:0xf bank_mask:0xf
  v_add_f32_dpp v14, v14, v14 row_ror:1 row_mask:0xf bank_mask:0xf
  v_add_f32_dpp v15, v15, v15 row_ror:1 row_mask:0xf bank_mask:0xf
  v_add_f32_dpp v16, v16, v16 row_ror:1 row_mask:0xf bank_mask:0xf
  v_add_f32_dpp v17, v17, v17 row_ror:1 row_mask:0xf bank_mask:0xf
  v_cvt_pk_bf16_f32 v20, v14, v15
  v_cvt_pk_bf16_f32 v23, v16, v17
  v_lshlrev_b32 v18, 16, v20
  v_and_b32 v19, s78, v20
  v_lshlrev_b32 v21, 16, v23
  v_and_b32 v22, s78, v23
  v_mul_f32 v18, s76, v18
  v_mul_f32 v19, s76, v19
  v_mul_f32 v21, s76, v21
  v_mul_f32 v22, s76, v22
  v_max3_f32 v24, v18, v19, v24
  v_cvt_pk_bf16_f32 v36, v18, v19
  v_max3_f32 v24, v21, v22, v24
  v_cvt_pk_bf16_f32 v37, v21, v22
  buffer_load_dwordx4 v[104:107], v1, s[40:43], s72 offen offset:2048 nt
  s_waitcnt lgkmcnt(0)
  v_dot2_f32_bf16 v14, v240, v2, 0
  v_dot2_f32_bf16 v15, v244, v2, 0
  v_dot2_f32_bf16 v16, v248, v2, 0
  v_dot2_f32_bf16 v17, v252, v2, 0
  v_dot2c_f32_bf16 v14, v241, v3
  v_dot2c_f32_bf16 v15, v245, v3
  v_dot2c_f32_bf16 v16, v249, v3
  v_dot2c_f32_bf16 v17, v253, v3
  v_dot2c_f32_bf16 v14, v242, v4
  v_dot2c_f32_bf16 v15, v246, v4
  v_dot2c_f32_bf16 v16, v250, v4
  v_dot2c_f32_bf16 v17, v254, v4
  v_dot2c_f32_bf16 v14, v243, v5
  v_dot2c_f32_bf16 v15, v247, v5
  v_dot2c_f32_bf16 v16, v251, v5
  v_dot2c_f32_bf16 v17, v255, v5
  s_waitcnt vmcnt(63)
  ds_read_b128 v[240:243], v27 offset:16384
  ds_read_b128 v[244:247], v27 offset:17408
  ds_read_b128 v[248:251], v27 offset:18432
  ds_read_b128 v[252:255], v27 offset:19456
  v_add_f32_dpp v14, v14, v14 row_ror:8 row_mask:0xf bank_mask:0xf
  v_add_f32_dpp v15, v15, v15 row_ror:8 row_mask:0xf bank_mask:0xf
  v_add_f32_dpp v16, v16, v16 row_ror:8 row_mask:0xf bank_mask:0xf
  v_add_f32_dpp v17, v17, v17 row_ror:8 row_mask:0xf bank_mask:0xf
  v_add_f32_dpp v14, v14, v14 row_ror:4 row_mask:0xf bank_mask:0xf
  v_add_f32_dpp v15, v15, v15 row_ror:4 row_mask:0xf bank_mask:0xf
  v_add_f32_dpp v16, v16, v16 row_ror:4 row_mask:0xf bank_mask:0xf
  v_add_f32_dpp v17, v17, v17 row_ror:4 row_mask:0xf bank_mask:0xf
  v_add_f32_dpp v14, v14, v14 row_ror:2 row_mask:0xf bank_mask:0xf
  v_add_f32_dpp v15, v15, v15 row_ror:2 row_mask:0xf bank_mask:0xf
  v_add_f32_dpp v16, v16, v16 row_ror:2 row_mask:0xf bank_mask:0xf
  v_add_f32_dpp v17, v17, v17 row_ror:2 row_mask:0xf bank_mask:0xf
  v_add_f32_dpp v14, v14, v14 row_ror:1 row_mask:0xf bank_mask:0xf
  v_add_f32_dpp v15, v15, v15 row_ror:1 row_mask:0xf bank_mask:0xf
  v_add_f32_dpp v16, v16, v16 row_ror:1 row_mask:0xf bank_mask:0xf
  v_add_f32_dpp v17, v17, v17 row_ror:1 row_mask:0xf bank_mask:0xf
  v_cvt_pk_bf16_f32 v20, v14, v15
  v_cvt_pk_bf16_f32 v23, v16, v17
  v_lshlrev_b32 v18, 16, v20
  v_and_b32 v19, s78, v20
  v_lshlrev_b32 v21, 16, v23
  v_and_b32 v22, s78, v23
  v_mul_f32 v18, s76, v18
  v_mul_f32 v19, s76, v19
  v_mul_f32 v21, s76, v21
  v_mul_f32 v22, s76, v22
  v_max3_f32 v24, v18, v19, v24
  v_cvt_pk_bf16_f32 v38, v18, v19
  v_max3_f32 v24, v21, v22, v24
  v_cvt_pk_bf16_f32 v39, v21, v22
  buffer_load_dwordx4 v[108:111], v1, s[40:43], s72 offen offset:3072 nt
  s_waitcnt lgkmcnt(0)
  v_dot2_f32_bf16 v14, v240, v2, 0
  v_dot2_f32_bf16 v15, v244, v2, 0
  v_dot2_f32_bf16 v16, v248, v2, 0
  v_dot2_f32_bf16 v17, v252, v2, 0
  v_dot2c_f32_bf16 v14, v241, v3
  v_dot2c_f32_bf16 v15, v245, v3
  v_dot2c_f32_bf16 v16, v249, v3
  v_dot2c_f32_bf16 v17, v253, v3
  v_dot2c_f32_bf16 v14, v242, v4
  v_dot2c_f32_bf16 v15, v246, v4
  v_dot2c_f32_bf16 v16, v250, v4
  v_dot2c_f32_bf16 v17, v254, v4
  v_dot2c_f32_bf16 v14, v243, v5
  v_dot2c_f32_bf16 v15, v247, v5
  v_dot2c_f32_bf16 v16, v251, v5
  v_dot2c_f32_bf16 v17, v255, v5
  s_waitcnt vmcnt(63)
  ds_read_b128 v[240:243], v27 offset:20480
  ds_read_b128 v[244:247], v27 offset:21504
  ds_read_b128 v[248:251], v27 offset:22528
  ds_read_b128 v[252:255], v27 offset:23552
  v_add_f32_dpp v14, v14, v14 row_ror:8 row_mask:0xf bank_mask:0xf
  v_add_f32_dpp v15, v15, v15 row_ror:8 row_mask:0xf bank_mask:0xf
  v_add_f32_dpp v16, v16, v16 row_ror:8 row_mask:0xf bank_mask:0xf
  v_add_f32_dpp v17, v17, v17 row_ror:8 row_mask:0xf bank_mask:0xf
  v_add_f32_dpp v14, v14, v14 row_ror:4 row_mask:0xf bank_mask:0xf
  v_add_f32_dpp v15, v15, v15 row_ror:4 row_mask:0xf bank_mask:0xf
  v_add_f32_dpp v16, v16, v16 row_ror:4 row_mask:0xf bank_mask:0xf
  v_add_f32_dpp v17, v17, v17 row_ror:4 row_mask:0xf bank_mask:0xf
  v_add_f32_dpp v14, v14, v14 row_ror:2 row_mask:0xf bank_mask:0xf
  v_add_f32_dpp v15, v15, v15 row_ror:2 row_mask:0xf bank_mask:0xf
  v_add_f32_dpp v16, v16, v16 row_ror:2 row_mask:0xf bank_mask:0xf
  v_add_f32_dpp v17, v17, v17 row_ror:2 row_mask:0xf bank_mask:0xf
  v_add_f32_dpp v14, v14, v14 row_ror:1 row_mask:0xf bank_mask:0xf
  v_add_f32_dpp v15, v15, v15 row_ror:1 row_mask:0xf bank_mask:0xf
  v_add_f32_dpp v16, v16, v16 row_ror:1 row_mask:0xf bank_mask:0xf
  v_add_f32_dpp v17, v17, v17 row_ror:1 row_mask:0xf bank_mask:0xf
  v_cvt_pk_bf16_f32 v20, v14, v15
  v_cvt_pk_bf16_f32 v23, v16, v17
  v_lshlrev_b32 v18, 16, v20
  v_and_b32 v19, s78, v20
  v_lshlrev_b32 v21, 16, v23
  v_and_b32 v22, s78, v23
  v_mul_f32 v18, s76, v18
  v_mul_f32 v19, s76, v19
  v_mul_f32 v21, s76, v21
  v_mul_f32 v22, s76, v22
  v_max3_f32 v24, v18, v19, v24
  v_cvt_pk_bf16_f32 v40, v18, v19
  v_max3_f32 v24, v21, v22, v24
  v_cvt_pk_bf16_f32 v41, v21, v22
  s_mov_b32 s72, 98304
  buffer_load_dwordx4 v[112:115], v1, s[40:43], s72 offen offset:0 nt
  s_waitcnt lgkmcnt(0)
  v_dot2_f32_bf16 v14, v240, v2, 0
  v_dot2_f32_bf16 v15, v244, v2, 0
  v_dot2_f32_bf16 v16, v248, v2, 0
  v_dot2_f32_bf16 v17, v252, v2, 0
  v_dot2c_f32_bf16 v14, v241, v3
  v_dot2c_f32_bf16 v15, v245, v3
  v_dot2c_f32_bf16 v16, v249, v3
  v_dot2c_f32_bf16 v17, v253, v3
  v_dot2c_f32_bf16 v14, v242, v4
  v_dot2c_f32_bf16 v15, v246, v4
  v_dot2c_f32_bf16 v16, v250, v4
  v_dot2c_f32_bf16 v17, v254, v4
  v_dot2c_f32_bf16 v14, v243, v5
  v_dot2c_f32_bf16 v15, v247, v5
  v_dot2c_f32_bf16 v16, v251, v5
  v_dot2c_f32_bf16 v17, v255, v5
  s_waitcnt vmcnt(61)
  ds_read_b128 v[240:243], v27 offset:24576
  ds_read_b128 v[244:247], v27 offset:25600
  ds_read_b128 v[248:251], v27 offset:26624
  ds_read_b128 v[252:255], v27 offset:27648
  v_add_f32_dpp v14, v14, v14 row_ror:8 row_mask:0xf bank_mask:0xf
  v_add_f32_dpp v15, v15, v15 row_ror:8 row_mask:0xf bank_mask:0xf
  v_add_f32_dpp v16, v16, v16 row_ror:8 row_mask:0xf bank_mask:0xf
  v_add_f32_dpp v17, v17, v17 row_ror:8 row_mask:0xf bank_mask:0xf
  v_add_f32_dpp v14, v14, v14 row_ror:4 row_mask:0xf bank_mask:0xf
  v_add_f32_dpp v15, v15, v15 row_ror:4 row_mask:0xf bank_mask:0xf
  v_add_f32_dpp v16, v16, v16 row_ror:4 row_mask:0xf bank_mask:0xf
  v_add_f32_dpp v17, v17, v17 row_ror:4 row_mask:0xf bank_mask:0xf
  v_add_f32_dpp v14, v14, v14 row_ror:2 row_mask:0xf bank_mask:0xf
  v_add_f32_dpp v15, v15, v15 row_ror:2 row_mask:0xf bank_mask:0xf
  v_add_f32_dpp v16, v16, v16 row_ror:2 row_mask:0xf bank_mask:0xf
  v_add_f32_dpp v17, v17, v17 row_ror:2 row_mask:0xf bank_mask:0xf
  v_add_f32_dpp v14, v14, v14 row_ror:1 row_mask:0xf bank_mask:0xf
  v_add_f32_dpp v15, v15, v15 row_ror:1 row_mask:0xf bank_mask:0xf
  v_add_f32_dpp v16, v16, v16 row_ror:1 row_mask:0xf bank_mask:0xf
  v_add_f32_dpp v17, v17, v17 row_ror:1 row_mask:0xf bank_mask:0xf
  v_cvt_pk_bf16_f32 v20, v14, v15
  v_cvt_pk_bf16_f32 v23, v16, v17
  v_lshlrev_b32 v18, 16, v20
  v_and_b32 v19, s78, v20
  v_lshlrev_b32 v21, 16, v23
  v_and_b32 v22, s78, v23
  v_mul_f32 v18, s76, v18
  v_mul_f32 v19, s76, v19
  v_mul_f32 v21, s76, v21
  v_mul_f32 v22, s76, v22
  v_max3_f32 v24, v18, v19, v24
  v_cvt_pk_bf16_f32 v42, v18, v19
  v_max3_f32 v24, v21, v22, v24
  v_cvt_pk_bf16_f32 v43, v21, v22
  buffer_load_dwordx4 v[116:119], v1, s[40:43], s72 offen offset:1024 nt
  s_waitcnt lgkmcnt(0)
  v_dot2_f32_bf16 v14, v240, v2, 0
  v_dot2_f32_bf16 v15, v244, v2, 0
  v_dot2_f32_bf16 v16, v248, v2, 0
  v_dot2_f32_bf16 v17, v252, v2, 0
  v_dot2c_f32_bf16 v14, v241, v3
  v_dot2c_f32_bf16 v15, v245, v3
  v_dot2c_f32_bf16 v16, v249, v3
  v_dot2c_f32_bf16 v17, v253, v3
  v_dot2c_f32_bf16 v14, v242, v4
  v_dot2c_f32_bf16 v15, v246, v4
  v_dot2c_f32_bf16 v16, v250, v4
  v_dot2c_f32_bf16 v17, v254, v4
  v_dot2c_f32_bf16 v14, v243, v5
  v_dot2c_f32_bf16 v15, v247, v5
  v_dot2c_f32_bf16 v16, v251, v5
  v_dot2c_f32_bf16 v17, v255, v5
  s_waitcnt vmcnt(58)
  ds_read_b128 v[240:243], v27 offset:28672
  ds_read_b128 v[244:247], v27 offset:29696
  ds_read_b128 v[248:251], v27 offset:30720
  ds_read_b128 v[252:255], v27 offset:31744
  v_add_f32_dpp v14, v14, v14 row_ror:8 row_mask:0xf bank_mask:0xf
  v_add_f32_dpp v15, v15, v15 row_ror:8 row_mask:0xf bank_mask:0xf
  v_add_f32_dpp v16, v16, v16 row_ror:8 row_mask:0xf bank_mask:0xf
  v_add_f32_dpp v17, v17, v17 row_ror:8 row_mask:0xf bank_mask:0xf
  v_add_f32_dpp v14, v14, v14 row_ror:4 row_mask:0xf bank_mask:0xf
  v_add_f32_dpp v15, v15, v15 row_ror:4 row_mask:0xf bank_mask:0xf
  v_add_f32_dpp v16, v16, v16 row_ror:4 row_mask:0xf bank_mask:0xf
  v_add_f32_dpp v17, v17, v17 row_ror:4 row_mask:0xf bank_mask:0xf
  v_add_f32_dpp v14, v14, v14 row_ror:2 row_mask:0xf bank_mask:0xf
  v_add_f32_dpp v15, v15, v15 row_ror:2 row_mask:0xf bank_mask:0xf
  v_add_f32_dpp v16, v16, v16 row_ror:2 row_mask:0xf bank_mask:0xf
  v_add_f32_dpp v17, v17, v17 row_ror:2 row_mask:0xf bank_mask:0xf
  v_add_f32_dpp v14, v14, v14 row_ror:1 row_mask:0xf bank_mask:0xf
  v_add_f32_dpp v15, v15, v15 row_ror:1 row_mask:0xf bank_mask:0xf
  v_add_f32_dpp v16, v16, v16 row_ror:1 row_mask:0xf bank_mask:0xf
  v_add_f32_dpp v17, v17, v17 row_ror:1 row_mask:0xf bank_mask:0xf
  v_cvt_pk_bf16_f32 v20, v14, v15
  v_cvt_pk_bf16_f32 v23, v16, v17
  v_lshlrev_b32 v18, 16, v20
  v_and_b32 v19, s78, v20
  v_lshlrev_b32 v21, 16, v23
  v_and_b32 v22, s78, v23
  v_mul_f32 v18, s76, v18
  v_mul_f32 v19, s76, v19
  v_mul_f32 v21, s76, v21
  v_mul_f32 v22, s76, v22
  v_max3_f32 v24, v18, v19, v24
  v_cvt_pk_bf16_f32 v44, v18, v19
  v_max3_f32 v24, v21, v22, v24
  v_cvt_pk_bf16_f32 v45, v21, v22
  buffer_load_dwordx4 v[120:123], v1, s[40:43], s72 offen offset:2048 nt
  s_waitcnt lgkmcnt(0)
  v_dot2_f32_bf16 v14, v240, v2, 0
  v_dot2_f32_bf16 v15, v244, v2, 0
  v_dot2_f32_bf16 v16, v248, v2, 0
  v_dot2_f32_bf16 v17, v252, v2, 0
  v_dot2c_f32_bf16 v14, v241, v3
  v_dot2c_f32_bf16 v15, v245, v3
  v_dot2c_f32_bf16 v16, v249, v3
  v_dot2c_f32_bf16 v17, v253, v3
  v_dot2c_f32_bf16 v14, v242, v4
  v_dot2c_f32_bf16 v15, v246, v4
  v_dot2c_f32_bf16 v16, v250, v4
  v_dot2c_f32_bf16 v17, v254, v4
  v_dot2c_f32_bf16 v14, v243, v5
  v_dot2c_f32_bf16 v15, v247, v5
  v_dot2c_f32_bf16 v16, v251, v5
  v_dot2c_f32_bf16 v17, v255, v5
  v_add_f32_dpp v14, v14, v14 row_ror:8 row_mask:0xf bank_mask:0xf
  v_add_f32_dpp v15, v15, v15 row_ror:8 row_mask:0xf bank_mask:0xf
  v_add_f32_dpp v16, v16, v16 row_ror:8 row_mask:0xf bank_mask:0xf
  v_add_f32_dpp v17, v17, v17 row_ror:8 row_mask:0xf bank_mask:0xf
  v_add_f32_dpp v14, v14, v14 row_ror:4 row_mask:0xf bank_mask:0xf
  v_add_f32_dpp v15, v15, v15 row_ror:4 row_mask:0xf bank_mask:0xf
  v_add_f32_dpp v16, v16, v16 row_ror:4 row_mask:0xf bank_mask:0xf
  v_add_f32_dpp v17, v17, v17 row_ror:4 row_mask:0xf bank_mask:0xf
  v_add_f32_dpp v14, v14, v14 row_ror:2 row_mask:0xf bank_mask:0xf
  v_add_f32_dpp v15, v15, v15 row_ror:2 row_mask:0xf bank_mask:0xf
  v_add_f32_dpp v16, v16, v16 row_ror:2 row_mask:0xf bank_mask:0xf
  v_add_f32_dpp v17, v17, v17 row_ror:2 row_mask:0xf bank_mask:0xf
  v_add_f32_dpp v14, v14, v14 row_ror:1 row_mask:0xf bank_mask:0xf
  v_add_f32_dpp v15, v15, v15 row_ror:1 row_mask:0xf bank_mask:0xf
  v_add_f32_dpp v16, v16, v16 row_ror:1 row_mask:0xf bank_mask:0xf
  v_add_f32_dpp v17, v17, v17 row_ror:1 row_mask:0xf bank_mask:0xf
  v_cvt_pk_bf16_f32 v20, v14, v15
  v_cvt_pk_bf16_f32 v23, v16, v17
  v_lshlrev_b32 v18, 16, v20
  v_and_b32 v19, s78, v20
  v_lshlrev_b32 v21, 16, v23
  v_and_b32 v22, s78, v23
  v_mul_f32 v18, s76, v18
  v_mul_f32 v19, s76, v19
  v_mul_f32 v21, s76, v21
  v_mul_f32 v22, s76, v22
  v_max3_f32 v24, v18, v19, v24
  v_cvt_pk_bf16_f32 v46, v18, v19
  v_max3_f32 v24, v21, v22, v24
  v_cvt_pk_bf16_f32 v47, v21, v22
  buffer_load_dwordx4 v[124:127], v1, s[40:43], s72 offen offset:3072 nt
  v_mov_b32 v18, v24
  s_nop 1
  v_permlane16_swap_b32 v24, v18
  s_nop 1
  v_max_f32 v24, v24, v18
  v_mov_b32 v18, v24
  s_nop 1
  v_permlane32_swap_b32 v24, v18
  s_nop 1
  v_max_f32 v24, v24, v18
  v_cvt_pk_bf16_f32 v24, v24, v24
  v_and_b32 v24, s78, v24
  v_mul_f32 v25, 0xbfb8aa3b, v24
  v_mov_b32 v26, 0
  v_lshlrev_b32 v18, 16, v32
  v_and_b32 v19, s78, v32
  v_fma_f32 v18, v18, s77, v25
  v_fma_f32 v19, v19, s77, v25
  v_exp_f32 v18, v18
  v_exp_f32 v19, v19
  s_nop 0
  v_cvt_pk_bf16_f32 v32, v18, v19
  v_add_f32 v18, v18, v19
  v_add_f32 v26, v26, v18
  v_lshlrev_b32 v20, 16, v33
  v_and_b32 v21, s78, v33
  v_fma_f32 v20, v20, s77, v25
  v_fma_f32 v21, v21, s77, v25
  v_exp_f32 v20, v20
  v_exp_f32 v21, v21
  s_nop 0
  v_cvt_pk_bf16_f32 v33, v20, v21
  v_add_f32 v20, v20, v21
  v_add_f32 v26, v26, v20
  v_lshlrev_b32 v18, 16, v34
  v_and_b32 v19, s78, v34
  v_fma_f32 v18, v18, s77, v25
  v_fma_f32 v19, v19, s77, v25
  v_exp_f32 v18, v18
  v_exp_f32 v19, v19
  s_nop 0
  v_cvt_pk_bf16_f32 v34, v18, v19
  v_add_f32 v18, v18, v19
  v_add_f32 v26, v26, v18
  v_lshlrev_b32 v20, 16, v35
  v_and_b32 v21, s78, v35
  v_fma_f32 v20, v20, s77, v25
  v_fma_f32 v21, v21, s77, v25
  v_exp_f32 v20, v20
  v_exp_f32 v21, v21
  s_nop 0
  v_cvt_pk_bf16_f32 v35, v20, v21
  v_add_f32 v20, v20, v21
  v_add_f32 v26, v26, v20
  s_mov_b32 s72, 114688
  buffer_load_dwordx4 v[128:131], v1, s[40:43], s72 offen offset:0 nt
  v_lshlrev_b32 v18, 16, v36
  v_and_b32 v19, s78, v36
  v_fma_f32 v18, v18, s77, v25
  v_fma_f32 v19, v19, s77, v25
  v_exp_f32 v18, v18
  v_exp_f32 v19, v19
  s_nop 0
  v_cvt_pk_bf16_f32 v36, v18, v19
  v_add_f32 v18, v18, v19
  v_add_f32 v26, v26, v18
  v_lshlrev_b32 v20, 16, v37
  v_and_b32 v21, s78, v37
  v_fma_f32 v20, v20, s77, v25
  v_fma_f32 v21, v21, s77, v25
  v_exp_f32 v20, v20
  v_exp_f32 v21, v21
  s_nop 0
  v_cvt_pk_bf16_f32 v37, v20, v21
  v_add_f32 v20, v20, v21
  v_add_f32 v26, v26, v20
  v_lshlrev_b32 v18, 16, v38
  v_and_b32 v19, s78, v38
  v_fma_f32 v18, v18, s77, v25
  v_fma_f32 v19, v19, s77, v25
  v_exp_f32 v18, v18
  v_exp_f32 v19, v19
  s_nop 0
  v_cvt_pk_bf16_f32 v38, v18, v19
  v_add_f32 v18, v18, v19
  v_add_f32 v26, v26, v18
  v_lshlrev_b32 v20, 16, v39
  v_and_b32 v21, s78, v39
  v_fma_f32 v20, v20, s77, v25
  v_fma_f32 v21, v21, s77, v25
  v_exp_f32 v20, v20
  v_exp_f32 v21, v21
  s_nop 0
  v_cvt_pk_bf16_f32 v39, v20, v21
  v_add_f32 v20, v20, v21
  v_add_f32 v26, v26, v20
  buffer_load_dwordx4 v[132:135], v1, s[40:43], s72 offen offset:1024 nt
  v_lshlrev_b32 v18, 16, v40
  v_and_b32 v19, s78, v40
  v_fma_f32 v18, v18, s77, v25
  v_fma_f32 v19, v19, s77, v25
  v_exp_f32 v18, v18
  v_exp_f32 v19, v19
  s_nop 0
  v_cvt_pk_bf16_f32 v40, v18, v19
  v_add_f32 v18, v18, v19
  v_add_f32 v26, v26, v18
  v_lshlrev_b32 v20, 16, v41
  v_and_b32 v21, s78, v41
  v_fma_f32 v20, v20, s77, v25
  v_fma_f32 v21, v21, s77, v25
  v_exp_f32 v20, v20
  v_exp_f32 v21, v21
  s_nop 0
  v_cvt_pk_bf16_f32 v41, v20, v21
  v_add_f32 v20, v20, v21
  v_add_f32 v26, v26, v20
  v_lshlrev_b32 v18, 16, v42
  v_and_b32 v19, s78, v42
  v_fma_f32 v18, v18, s77, v25
  v_fma_f32 v19, v19, s77, v25
  v_exp_f32 v18, v18
  v_exp_f32 v19, v19
  s_nop 0
  v_cvt_pk_bf16_f32 v42, v18, v19
  v_add_f32 v18, v18, v19
  v_add_f32 v26, v26, v18
  v_lshlrev_b32 v20, 16, v43
  v_and_b32 v21, s78, v43
  v_fma_f32 v20, v20, s77, v25
  v_fma_f32 v21, v21, s77, v25
  v_exp_f32 v20, v20
  v_exp_f32 v21, v21
  s_nop 0
  v_cvt_pk_bf16_f32 v43, v20, v21
  v_add_f32 v20, v20, v21
  v_add_f32 v26, v26, v20
  buffer_load_dwordx4 v[136:139], v1, s[40:43], s72 offen offset:2048 nt
  v_lshlrev_b32 v18, 16, v44
  v_and_b32 v19, s78, v44
  v_fma_f32 v18, v18, s77, v25
  v_fma_f32 v19, v19, s77, v25
  v_exp_f32 v18, v18
  v_exp_f32 v19, v19
  s_nop 0
  v_cvt_pk_bf16_f32 v44, v18, v19
  v_add_f32 v18, v18, v19
  v_add_f32 v26, v26, v18
  v_lshlrev_b32 v20, 16, v45
  v_and_b32 v21, s78, v45
  v_fma_f32 v20, v20, s77, v25
  v_fma_f32 v21, v21, s77, v25
  v_exp_f32 v20, v20
  v_exp_f32 v21, v21
  s_nop 0
  v_cvt_pk_bf16_f32 v45, v20, v21
  v_add_f32 v20, v20, v21
  v_add_f32 v26, v26, v20
  v_lshlrev_b32 v18, 16, v46
  v_and_b32 v19, s78, v46
  v_fma_f32 v18, v18, s77, v25
  v_fma_f32 v19, v19, s77, v25
  v_exp_f32 v18, v18
  v_exp_f32 v19, v19
  s_nop 0
  v_cvt_pk_bf16_f32 v46, v18, v19
  v_add_f32 v18, v18, v19
  v_add_f32 v26, v26, v18
  v_lshlrev_b32 v20, 16, v47
  v_and_b32 v21, s78, v47
  v_fma_f32 v20, v20, s77, v25
  v_fma_f32 v21, v21, s77, v25
  v_exp_f32 v20, v20
  v_exp_f32 v21, v21
  s_nop 0
  v_cvt_pk_bf16_f32 v47, v20, v21
  v_add_f32 v20, v20, v21
  v_add_f32 v26, v26, v20
  buffer_load_dwordx4 v[140:143], v1, s[40:43], s72 offen offset:3072 nt
  v_lshlrev_b32 v18, 16, v48
  v_and_b32 v19, s78, v48
  v_fma_f32 v18, v18, s77, v25
  v_fma_f32 v19, v19, s77, v25
  v_exp_f32 v18, v18
  v_exp_f32 v19, v19
  s_nop 0
  v_cvt_pk_bf16_f32 v48, v18, v19
  v_add_f32 v18, v18, v19
  v_add_f32 v26, v26, v18
  v_lshlrev_b32 v20, 16, v49
  v_and_b32 v21, s78, v49
  v_fma_f32 v20, v20, s77, v25
  v_fma_f32 v21, v21, s77, v25
  v_exp_f32 v20, v20
  v_exp_f32 v21, v21
  s_nop 0
  v_cvt_pk_bf16_f32 v49, v20, v21
  v_add_f32 v20, v20, v21
  v_add_f32 v26, v26, v20
  v_lshlrev_b32 v18, 16, v50
  v_and_b32 v19, s78, v50
  v_fma_f32 v18, v18, s77, v25
  v_fma_f32 v19, v19, s77, v25
  v_exp_f32 v18, v18
  v_exp_f32 v19, v19
  s_nop 0
  v_cvt_pk_bf16_f32 v50, v18, v19
  v_add_f32 v18, v18, v19
  v_add_f32 v26, v26, v18
  v_lshlrev_b32 v20, 16, v51
  v_and_b32 v21, s78, v51
  v_fma_f32 v20, v20, s77, v25
  v_fma_f32 v21, v21, s77, v25
  v_exp_f32 v20, v20
  v_exp_f32 v21, v21
  s_nop 0
  v_cvt_pk_bf16_f32 v51, v20, v21
  v_add_f32 v20, v20, v21
  v_add_f32 v26, v26, v20
  s_mov_b32 s72, 131072
  buffer_load_dwordx4 v[144:147], v1, s[40:43], s72 offen offset:0 nt
  v_lshlrev_b32 v18, 16, v52
  v_and_b32 v19, s78, v52
  v_fma_f32 v18, v18, s77, v25
  v_fma_f32 v19, v19, s77, v25
  v_exp_f32 v18, v18
  v_exp_f32 v19, v19
  s_nop 0
  v_cvt_pk_bf16_f32 v52, v18, v19
  v_add_f32 v18, v18, v19
  v_add_f32 v26, v26, v18
  v_lshlrev_b32 v20, 16, v53
  v_and_b32 v21, s78, v53
  v_fma_f32 v20, v20, s77, v25
  v_fma_f32 v21, v21, s77, v25
  v_exp_f32 v20, v20
  v_exp_f32 v21, v21
  s_nop 0
  v_cvt_pk_bf16_f32 v53, v20, v21
  v_add_f32 v20, v20, v21
  v_add_f32 v26, v26, v20
  v_lshlrev_b32 v18, 16, v54
  v_and_b32 v19, s78, v54
  v_fma_f32 v18, v18, s77, v25
  v_fma_f32 v19, v19, s77, v25
  v_exp_f32 v18, v18
  v_exp_f32 v19, v19
  s_nop 0
  v_cvt_pk_bf16_f32 v54, v18, v19
  v_add_f32 v18, v18, v19
  v_add_f32 v26, v26, v18
  v_lshlrev_b32 v20, 16, v55
  v_and_b32 v21, s78, v55
  v_fma_f32 v20, v20, s77, v25
  v_fma_f32 v21, v21, s77, v25
  v_exp_f32 v20, v20
  v_exp_f32 v21, v21
  s_nop 0
  v_cvt_pk_bf16_f32 v55, v20, v21
  v_add_f32 v20, v20, v21
  v_add_f32 v26, v26, v20
  buffer_load_dwordx4 v[148:151], v1, s[40:43], s72 offen offset:1024 nt
  v_lshlrev_b32 v18, 16, v56
  v_and_b32 v19, s78, v56
  v_fma_f32 v18, v18, s77, v25
  v_fma_f32 v19, v19, s77, v25
  v_exp_f32 v18, v18
  v_exp_f32 v19, v19
  s_nop 0
  v_cvt_pk_bf16_f32 v56, v18, v19
  v_add_f32 v18, v18, v19
  v_add_f32 v26, v26, v18
  v_lshlrev_b32 v20, 16, v57
  v_and_b32 v21, s78, v57
  v_fma_f32 v20, v20, s77, v25
  v_fma_f32 v21, v21, s77, v25
  v_exp_f32 v20, v20
  v_exp_f32 v21, v21
  s_nop 0
  v_cvt_pk_bf16_f32 v57, v20, v21
  v_add_f32 v20, v20, v21
  v_add_f32 v26, v26, v20
  v_lshlrev_b32 v18, 16, v58
  v_and_b32 v19, s78, v58
  v_fma_f32 v18, v18, s77, v25
  v_fma_f32 v19, v19, s77, v25
  v_exp_f32 v18, v18
  v_exp_f32 v19, v19
  s_nop 0
  v_cvt_pk_bf16_f32 v58, v18, v19
  v_add_f32 v18, v18, v19
  v_add_f32 v26, v26, v18
  v_lshlrev_b32 v20, 16, v59
  v_and_b32 v21, s78, v59
  v_fma_f32 v20, v20, s77, v25
  v_fma_f32 v21, v21, s77, v25
  v_exp_f32 v20, v20
  v_exp_f32 v21, v21
  s_nop 0
  v_cvt_pk_bf16_f32 v59, v20, v21
  v_add_f32 v20, v20, v21
  v_add_f32 v26, v26, v20
  buffer_load_dwordx4 v[152:155], v1, s[40:43], s72 offen offset:2048 nt
  v_lshlrev_b32 v18, 16, v60
  v_and_b32 v19, s78, v60
  v_fma_f32 v18, v18, s77, v25
  v_fma_f32 v19, v19, s77, v25
  v_exp_f32 v18, v18
  v_exp_f32 v19, v19
  s_nop 0
  v_cvt_pk_bf16_f32 v60, v18, v19
  v_add_f32 v18, v18, v19
  v_add_f32 v26, v26, v18
  v_lshlrev_b32 v20, 16, v61
  v_and_b32 v21, s78, v61
  v_fma_f32 v20, v20, s77, v25
  v_fma_f32 v21, v21, s77, v25
  v_exp_f32 v20, v20
  v_exp_f32 v21, v21
  s_nop 0
  v_cvt_pk_bf16_f32 v61, v20, v21
  v_add_f32 v20, v20, v21
  v_add_f32 v26, v26, v20
  v_lshlrev_b32 v18, 16, v62
  v_and_b32 v19, s78, v62
  v_fma_f32 v18, v18, s77, v25
  v_fma_f32 v19, v19, s77, v25
  v_exp_f32 v18, v18
  v_exp_f32 v19, v19
  s_nop 0
  v_cvt_pk_bf16_f32 v62, v18, v19
  v_add_f32 v18, v18, v19
  v_add_f32 v26, v26, v18
  v_lshlrev_b32 v20, 16, v63
  v_and_b32 v21, s78, v63
  v_fma_f32 v20, v20, s77, v25
  v_fma_f32 v21, v21, s77, v25
  v_exp_f32 v20, v20
  v_exp_f32 v21, v21
  s_nop 0
  v_cvt_pk_bf16_f32 v63, v20, v21
  v_add_f32 v20, v20, v21
  v_add_f32 v26, v26, v20
  buffer_load_dwordx4 v[156:159], v1, s[40:43], s72 offen offset:3072 nt
  v_mov_b32 v18, v26
  s_nop 1
  v_permlane16_swap_b32 v26, v18
  s_nop 1
  v_add_f32 v26, v26, v18
  v_mov_b32 v18, v26
  s_nop 1
  v_permlane32_swap_b32 v26, v18
  s_nop 1
  v_add_f32 v26, v26, v18
  s_lshl_b32 s4, s3, 3
  v_mov_b32 v18, s4
  v_mov_b32 v20, v24
  v_mov_b32 v21, v26
  s_mov_b64 exec, 1
  ds_write_b64 v18, v[20:21] offset:12416
  s_mov_b64 exec, -1
  v_mov_b32 v18, 0
  v_mov_b32 v19, 1
  s_mov_b64 exec, 1
  ds_add_u32 v18, v19 offset:12560
  s_mov_b64 exec, -1
  v_lshlrev_b32 v25, 2, v0
  s_lshl_b32 s4, s3, 9
  v_add_u32 v25, s4, v25
  v_mov_b32 v26, 0
  v_mov_b32 v27, 1
  s_waitcnt vmcnt(35)
  v_and_b32 v14, 0xffff, v32
  v_lshlrev_b32 v15, 16, v32
  v_dot2c_f32_bf16 v6, v192, v14
  v_dot2c_f32_bf16 v7, v192, v15
  v_dot2c_f32_bf16 v8, v193, v14
  v_dot2c_f32_bf16 v9, v193, v15
  v_dot2c_f32_bf16 v10, v194, v14
  v_dot2c_f32_bf16 v11, v194, v15
  v_dot2c_f32_bf16 v12, v195, v14
  v_dot2c_f32_bf16 v13, v195, v15
  s_waitcnt vmcnt(34)
  v_lshrrev_b32 v16, 16, v32
  v_and_b32 v17, s78, v32
  v_dot2c_f32_bf16 v6, v196, v16
  v_dot2c_f32_bf16 v7, v196, v17
  v_dot2c_f32_bf16 v8, v197, v16
  v_dot2c_f32_bf16 v9, v197, v17
  v_dot2c_f32_bf16 v10, v198, v16
  v_dot2c_f32_bf16 v11, v198, v17
  v_dot2c_f32_bf16 v12, v199, v16
  v_dot2c_f32_bf16 v13, v199, v17
  s_mov_b32 s72, 147456
  buffer_load_dwordx4 v[160:163], v1, s[40:43], s72 offen offset:0 nt
  s_waitcnt vmcnt(34)
  v_and_b32 v14, 0xffff, v33
  v_lshlrev_b32 v15, 16, v33
  v_dot2c_f32_bf16 v6, v200, v14
  v_dot2c_f32_bf16 v7, v200, v15
  v_dot2c_f32_bf16 v8, v201, v14
  v_dot2c_f32_bf16 v9, v201, v15
  v_dot2c_f32_bf16 v10, v202, v14
  v_dot2c_f32_bf16 v11, v202, v15
  v_dot2c_f32_bf16 v12, v203, v14
  v_dot2c_f32_bf16 v13, v203, v15
  s_waitcnt vmcnt(33)
  v_lshrrev_b32 v16, 16, v33
  v_and_b32 v17, s78, v33
  v_dot2c_f32_bf16 v6, v204, v16
  v_dot2c_f32_bf16 v7, v204, v17
  v_dot2c_f32_bf16 v8, v205, v16
  v_dot2c_f32_bf16 v9, v205, v17
  v_dot2c_f32_bf16 v10, v206, v16
  v_dot2c_f32_bf16 v11, v206, v17
  v_dot2c_f32_bf16 v12, v207, v16
  v_dot2c_f32_bf16 v13, v207, v17
  s_waitcnt vmcnt(32)
  v_and_b32 v14, 0xffff, v34
  v_lshlrev_b32 v15, 16, v34
  v_dot2c_f32_bf16 v6, v208, v14
  v_dot2c_f32_bf16 v7, v208, v15
  v_dot2c_f32_bf16 v8, v209, v14
  v_dot2c_f32_bf16 v9, v209, v15
  v_dot2c_f32_bf16 v10, v210, v14
  v_dot2c_f32_bf16 v11, v210, v15
  v_dot2c_f32_bf16 v12, v211, v14
  v_dot2c_f32_bf16 v13, v211, v15
  buffer_load_dwordx4 v[164:167], v1, s[40:43], s72 offen offset:1024 nt
  s_waitcnt vmcnt(32)
  v_lshrrev_b32 v16, 16, v34
  v_and_b32 v17, s78, v34
  v_dot2c_f32_bf16 v6, v212, v16
  v_dot2c_f32_bf16 v7, v212, v17
  v_dot2c_f32_bf16 v8, v213, v16
  v_dot2c_f32_bf16 v9, v213, v17
  v_dot2c_f32_bf16 v10, v214, v16
  v_dot2c_f32_bf16 v11, v214, v17
  v_dot2c_f32_bf16 v12, v215, v16
  v_dot2c_f32_bf16 v13, v215, v17
  s_waitcnt vmcnt(31)
  v_and_b32 v14, 0xffff, v35
  v_lshlrev_b32 v15, 16, v35
  v_dot2c_f32_bf16 v6, v216, v14
  v_dot2c_f32_bf16 v7, v216, v15
  v_dot2c_f32_bf16 v8, v217, v14
  v_dot2c_f32_bf16 v9, v217, v15
  v_dot2c_f32_bf16 v10, v218, v14
  v_dot2c_f32_bf16 v11, v218, v15
  v_dot2c_f32_bf16 v12, v219, v14
  v_dot2c_f32_bf16 v13, v219, v15
  s_waitcnt vmcnt(30)
  v_lshrrev_b32 v16, 16, v35
  v_and_b32 v17, s78, v35
  v_dot2c_f32_bf16 v6, v220, v16
  v_dot2c_f32_bf16 v7, v220, v17
  v_dot2c_f32_bf16 v8, v221, v16
  v_dot2c_f32_bf16 v9, v221, v17
  v_dot2c_f32_bf16 v10, v222, v16
  v_dot2c_f32_bf16 v11, v222, v17
  v_dot2c_f32_bf16 v12, v223, v16
  v_dot2c_f32_bf16 v13, v223, v17
  buffer_load_dwordx4 v[168:171], v1, s[40:43], s72 offen offset:2048 nt
  s_waitcnt vmcnt(30)
  v_and_b32 v14, 0xffff, v36
  v_lshlrev_b32 v15, 16, v36
  v_dot2c_f32_bf16 v6, v224, v14
  v_dot2c_f32_bf16 v7, v224, v15
  v_dot2c_f32_bf16 v8, v225, v14
  v_dot2c_f32_bf16 v9, v225, v15
  v_dot2c_f32_bf16 v10, v226, v14
  v_dot2c_f32_bf16 v11, v226, v15
  v_dot2c_f32_bf16 v12, v227, v14
  v_dot2c_f32_bf16 v13, v227, v15
  s_waitcnt vmcnt(29)
  v_lshrrev_b32 v16, 16, v36
  v_and_b32 v17, s78, v36
  v_dot2c_f32_bf16 v6, v228, v16
  v_dot2c_f32_bf16 v7, v228, v17
  v_dot2c_f32_bf16 v8, v229, v16
  v_dot2c_f32_bf16 v9, v229, v17
  v_dot2c_f32_bf16 v10, v230, v16
  v_dot2c_f32_bf16 v11, v230, v17
  v_dot2c_f32_bf16 v12, v231, v16
  v_dot2c_f32_bf16 v13, v231, v17
  s_waitcnt vmcnt(28)
  v_and_b32 v14, 0xffff, v37
  v_lshlrev_b32 v15, 16, v37
  v_dot2c_f32_bf16 v6, v232, v14
  v_dot2c_f32_bf16 v7, v232, v15
  v_dot2c_f32_bf16 v8, v233, v14
  v_dot2c_f32_bf16 v9, v233, v15
  v_dot2c_f32_bf16 v10, v234, v14
  v_dot2c_f32_bf16 v11, v234, v15
  v_dot2c_f32_bf16 v12, v235, v14
  v_dot2c_f32_bf16 v13, v235, v15
  buffer_load_dwordx4 v[172:175], v1, s[40:43], s72 offen offset:3072 nt
  s_waitcnt vmcnt(28)
  v_lshrrev_b32 v16, 16, v37
  v_and_b32 v17, s78, v37
  v_dot2c_f32_bf16 v6, v236, v16
  v_dot2c_f32_bf16 v7, v236, v17
  v_dot2c_f32_bf16 v8, v237, v16
  v_dot2c_f32_bf16 v9, v237, v17
  v_dot2c_f32_bf16 v10, v238, v16
  v_dot2c_f32_bf16 v11, v238, v17
  v_dot2c_f32_bf16 v12, v239, v16
  v_dot2c_f32_bf16 v13, v239, v17
  s_waitcnt vmcnt(27)
  v_and_b32 v14, 0xffff, v38
  v_lshlrev_b32 v15, 16, v38
  v_dot2c_f32_bf16 v6, v64, v14
  v_dot2c_f32_bf16 v7, v64, v15
  v_dot2c_f32_bf16 v8, v65, v14
  v_dot2c_f32_bf16 v9, v65, v15
  v_dot2c_f32_bf16 v10, v66, v14
  v_dot2c_f32_bf16 v11, v66, v15
  v_dot2c_f32_bf16 v12, v67, v14
  v_dot2c_f32_bf16 v13, v67, v15
  s_waitcnt vmcnt(26)
  v_lshrrev_b32 v16, 16, v38
  v_and_b32 v17, s78, v38
  v_dot2c_f32_bf16 v6, v68, v16
  v_dot2c_f32_bf16 v7, v68, v17
  v_dot2c_f32_bf16 v8, v69, v16
  v_dot2c_f32_bf16 v9, v69, v17
  v_dot2c_f32_bf16 v10, v70, v16
  v_dot2c_f32_bf16 v11, v70, v17
  v_dot2c_f32_bf16 v12, v71, v16
  v_dot2c_f32_bf16 v13, v71, v17
  s_mov_b32 s72, 163840
  buffer_load_dwordx4 v[176:179], v1, s[40:43], s72 offen offset:0 nt
  s_waitcnt vmcnt(26)
  v_and_b32 v14, 0xffff, v39
  v_lshlrev_b32 v15, 16, v39
  v_dot2c_f32_bf16 v6, v72, v14
  v_dot2c_f32_bf16 v7, v72, v15
  v_dot2c_f32_bf16 v8, v73, v14
  v_dot2c_f32_bf16 v9, v73, v15
  v_dot2c_f32_bf16 v10, v74, v14
  v_dot2c_f32_bf16 v11, v74, v15
  v_dot2c_f32_bf16 v12, v75, v14
  v_dot2c_f32_bf16 v13, v75, v15
  s_waitcnt vmcnt(25)
  v_lshrrev_b32 v16, 16, v39
  v_and_b32 v17, s78, v39
  v_dot2c_f32_bf16 v6, v76, v16
  v_dot2c_f32_bf16 v7, v76, v17
  v_dot2c_f32_bf16 v8, v77, v16
  v_dot2c_f32_bf16 v9, v77, v17
  v_dot2c_f32_bf16 v10, v78, v16
  v_dot2c_f32_bf16 v11, v78, v17
  v_dot2c_f32_bf16 v12, v79, v16
  v_dot2c_f32_bf16 v13, v79, v17
  s_waitcnt vmcnt(24)
  v_and_b32 v14, 0xffff, v40
  v_lshlrev_b32 v15, 16, v40
  v_dot2c_f32_bf16 v6, v80, v14
  v_dot2c_f32_bf16 v7, v80, v15
  v_dot2c_f32_bf16 v8, v81, v14
  v_dot2c_f32_bf16 v9, v81, v15
  v_dot2c_f32_bf16 v10, v82, v14
  v_dot2c_f32_bf16 v11, v82, v15
  v_dot2c_f32_bf16 v12, v83, v14
  v_dot2c_f32_bf16 v13, v83, v15
  buffer_load_dwordx4 v[180:183], v1, s[40:43], s72 offen offset:1024 nt
  s_waitcnt vmcnt(24)
  v_lshrrev_b32 v16, 16, v40
  v_and_b32 v17, s78, v40
  v_dot2c_f32_bf16 v6, v84, v16
  v_dot2c_f32_bf16 v7, v84, v17
  v_dot2c_f32_bf16 v8, v85, v16
  v_dot2c_f32_bf16 v9, v85, v17
  v_dot2c_f32_bf16 v10, v86, v16
  v_dot2c_f32_bf16 v11, v86, v17
  v_dot2c_f32_bf16 v12, v87, v16
  v_dot2c_f32_bf16 v13, v87, v17
  s_waitcnt vmcnt(23)
  v_and_b32 v14, 0xffff, v41
  v_lshlrev_b32 v15, 16, v41
  v_dot2c_f32_bf16 v6, v88, v14
  v_dot2c_f32_bf16 v7, v88, v15
  v_dot2c_f32_bf16 v8, v89, v14
  v_dot2c_f32_bf16 v9, v89, v15
  v_dot2c_f32_bf16 v10, v90, v14
  v_dot2c_f32_bf16 v11, v90, v15
  v_dot2c_f32_bf16 v12, v91, v14
  v_dot2c_f32_bf16 v13, v91, v15
  s_waitcnt vmcnt(22)
  v_lshrrev_b32 v16, 16, v41
  v_and_b32 v17, s78, v41
  v_dot2c_f32_bf16 v6, v92, v16
  v_dot2c_f32_bf16 v7, v92, v17
  v_dot2c_f32_bf16 v8, v93, v16
  v_dot2c_f32_bf16 v9, v93, v17
  v_dot2c_f32_bf16 v10, v94, v16
  v_dot2c_f32_bf16 v11, v94, v17
  v_dot2c_f32_bf16 v12, v95, v16
  v_dot2c_f32_bf16 v13, v95, v17
  buffer_load_dwordx4 v[184:187], v1, s[40:43], s72 offen offset:2048 nt
  s_waitcnt vmcnt(22)
  v_and_b32 v14, 0xffff, v42
  v_lshlrev_b32 v15, 16, v42
  v_dot2c_f32_bf16 v6, v96, v14
  v_dot2c_f32_bf16 v7, v96, v15
  v_dot2c_f32_bf16 v8, v97, v14
  v_dot2c_f32_bf16 v9, v97, v15
  v_dot2c_f32_bf16 v10, v98, v14
  v_dot2c_f32_bf16 v11, v98, v15
  v_dot2c_f32_bf16 v12, v99, v14
  v_dot2c_f32_bf16 v13, v99, v15
  s_waitcnt vmcnt(21)
  v_lshrrev_b32 v16, 16, v42
  v_and_b32 v17, s78, v42
  v_dot2c_f32_bf16 v6, v100, v16
  v_dot2c_f32_bf16 v7, v100, v17
  v_dot2c_f32_bf16 v8, v101, v16
  v_dot2c_f32_bf16 v9, v101, v17
  v_dot2c_f32_bf16 v10, v102, v16
  v_dot2c_f32_bf16 v11, v102, v17
  v_dot2c_f32_bf16 v12, v103, v16
  v_dot2c_f32_bf16 v13, v103, v17
  s_waitcnt vmcnt(20)
  v_and_b32 v14, 0xffff, v43
  v_lshlrev_b32 v15, 16, v43
  v_dot2c_f32_bf16 v6, v104, v14
  v_dot2c_f32_bf16 v7, v104, v15
  v_dot2c_f32_bf16 v8, v105, v14
  v_dot2c_f32_bf16 v9, v105, v15
  v_dot2c_f32_bf16 v10, v106, v14
  v_dot2c_f32_bf16 v11, v106, v15
  v_dot2c_f32_bf16 v12, v107, v14
  v_dot2c_f32_bf16 v13, v107, v15
  buffer_load_dwordx4 v[188:191], v1, s[40:43], s72 offen offset:3072 nt
  s_waitcnt vmcnt(20)
  v_lshrrev_b32 v16, 16, v43
  v_and_b32 v17, s78, v43
  v_dot2c_f32_bf16 v6, v108, v16
  v_dot2c_f32_bf16 v7, v108, v17
  v_dot2c_f32_bf16 v8, v109, v16
  v_dot2c_f32_bf16 v9, v109, v17
  v_dot2c_f32_bf16 v10, v110, v16
  v_dot2c_f32_bf16 v11, v110, v17
  v_dot2c_f32_bf16 v12, v111, v16
  v_dot2c_f32_bf16 v13, v111, v17
  s_waitcnt vmcnt(19)
  v_and_b32 v14, 0xffff, v44
  v_lshlrev_b32 v15, 16, v44
  v_dot2c_f32_bf16 v6, v112, v14
  v_dot2c_f32_bf16 v7, v112, v15
  v_dot2c_f32_bf16 v8, v113, v14
  v_dot2c_f32_bf16 v9, v113, v15
  v_dot2c_f32_bf16 v10, v114, v14
  v_dot2c_f32_bf16 v11, v114, v15
  v_dot2c_f32_bf16 v12, v115, v14
  v_dot2c_f32_bf16 v13, v115, v15
  s_waitcnt vmcnt(18)
  v_lshrrev_b32 v16, 16, v44
  v_and_b32 v17, s78, v44
  v_dot2c_f32_bf16 v6, v116, v16
  v_dot2c_f32_bf16 v7, v116, v17
  v_dot2c_f32_bf16 v8, v117, v16
  v_dot2c_f32_bf16 v9, v117, v17
  v_dot2c_f32_bf16 v10, v118, v16
  v_dot2c_f32_bf16 v11, v118, v17
  v_dot2c_f32_bf16 v12, v119, v16
  v_dot2c_f32_bf16 v13, v119, v17
  s_mov_b32 s72, 180224
  buffer_load_dwordx4 v[192:195], v1, s[40:43], s72 offen offset:0 nt
  s_waitcnt vmcnt(18)
  v_and_b32 v14, 0xffff, v45
  v_lshlrev_b32 v15, 16, v45
  v_dot2c_f32_bf16 v6, v120, v14
  v_dot2c_f32_bf16 v7, v120, v15
  v_dot2c_f32_bf16 v8, v121, v14
  v_dot2c_f32_bf16 v9, v121, v15
  v_dot2c_f32_bf16 v10, v122, v14
  v_dot2c_f32_bf16 v11, v122, v15
  v_dot2c_f32_bf16 v12, v123, v14
  v_dot2c_f32_bf16 v13, v123, v15
  s_waitcnt vmcnt(17)
  v_lshrrev_b32 v16, 16, v45
  v_and_b32 v17, s78, v45
  v_dot2c_f32_bf16 v6, v124, v16
  v_dot2c_f32_bf16 v7, v124, v17
  v_dot2c_f32_bf16 v8, v125, v16
  v_dot2c_f32_bf16 v9, v125, v17
  v_dot2c_f32_bf16 v10, v126, v16
  v_dot2c_f32_bf16 v11, v126, v17
  v_dot2c_f32_bf16 v12, v127, v16
  v_dot2c_f32_bf16 v13, v127, v17
  s_waitcnt vmcnt(16)
  v_and_b32 v14, 0xffff, v46
  v_lshlrev_b32 v15, 16, v46
  v_dot2c_f32_bf16 v6, v128, v14
  v_dot2c_f32_bf16 v7, v128, v15
  v_dot2c_f32_bf16 v8, v129, v14
  v_dot2c_f32_bf16 v9, v129, v15
  v_dot2c_f32_bf16 v10, v130, v14
  v_dot2c_f32_bf16 v11, v130, v15
  v_dot2c_f32_bf16 v12, v131, v14
  v_dot2c_f32_bf16 v13, v131, v15
  buffer_load_dwordx4 v[196:199], v1, s[40:43], s72 offen offset:1024 nt
  s_waitcnt vmcnt(16)
  v_lshrrev_b32 v16, 16, v46
  v_and_b32 v17, s78, v46
  v_dot2c_f32_bf16 v6, v132, v16
  v_dot2c_f32_bf16 v7, v132, v17
  v_dot2c_f32_bf16 v8, v133, v16
  v_dot2c_f32_bf16 v9, v133, v17
  v_dot2c_f32_bf16 v10, v134, v16
  v_dot2c_f32_bf16 v11, v134, v17
  v_dot2c_f32_bf16 v12, v135, v16
  v_dot2c_f32_bf16 v13, v135, v17
  s_waitcnt vmcnt(15)
  v_and_b32 v14, 0xffff, v47
  v_lshlrev_b32 v15, 16, v47
  v_dot2c_f32_bf16 v6, v136, v14
  v_dot2c_f32_bf16 v7, v136, v15
  v_dot2c_f32_bf16 v8, v137, v14
  v_dot2c_f32_bf16 v9, v137, v15
  v_dot2c_f32_bf16 v10, v138, v14
  v_dot2c_f32_bf16 v11, v138, v15
  v_dot2c_f32_bf16 v12, v139, v14
  v_dot2c_f32_bf16 v13, v139, v15
  s_waitcnt vmcnt(14)
  v_lshrrev_b32 v16, 16, v47
  v_and_b32 v17, s78, v47
  v_dot2c_f32_bf16 v6, v140, v16
  v_dot2c_f32_bf16 v7, v140, v17
  v_dot2c_f32_bf16 v8, v141, v16
  v_dot2c_f32_bf16 v9, v141, v17
  v_dot2c_f32_bf16 v10, v142, v16
  v_dot2c_f32_bf16 v11, v142, v17
  v_dot2c_f32_bf16 v12, v143, v16
  v_dot2c_f32_bf16 v13, v143, v17
  buffer_load_dwordx4 v[200:203], v1, s[40:43], s72 offen offset:2048 nt
  s_waitcnt vmcnt(14)
  v_and_b32 v14, 0xffff, v48
  v_lshlrev_b32 v15, 16, v48
  v_dot2c_f32_bf16 v6, v144, v14
  v_dot2c_f32_bf16 v7, v144, v15
  v_dot2c_f32_bf16 v8, v145, v14
  v_dot2c_f32_bf16 v9, v145, v15
  v_dot2c_f32_bf16 v10, v146, v14
  v_dot2c_f32_bf16 v11, v146, v15
  v_dot2c_f32_bf16 v12, v147, v14
  v_dot2c_f32_bf16 v13, v147, v15
  s_waitcnt vmcnt(13)
  v_lshrrev_b32 v16, 16, v48
  v_and_b32 v17, s78, v48
  v_dot2c_f32_bf16 v6, v148, v16
  v_dot2c_f32_bf16 v7, v148, v17
  v_dot2c_f32_bf16 v8, v149, v16
  v_dot2c_f32_bf16 v9, v149, v17
  v_dot2c_f32_bf16 v10, v150, v16
  v_dot2c_f32_bf16 v11, v150, v17
  v_dot2c_f32_bf16 v12, v151, v16
  v_dot2c_f32_bf16 v13, v151, v17
  s_waitcnt vmcnt(12)
  v_and_b32 v14, 0xffff, v49
  v_lshlrev_b32 v15, 16, v49
  v_dot2c_f32_bf16 v6, v152, v14
  v_dot2c_f32_bf16 v7, v152, v15
  v_dot2c_f32_bf16 v8, v153, v14
  v_dot2c_f32_bf16 v9, v153, v15
  v_dot2c_f32_bf16 v10, v154, v14
  v_dot2c_f32_bf16 v11, v154, v15
  v_dot2c_f32_bf16 v12, v155, v14
  v_dot2c_f32_bf16 v13, v155, v15
  buffer_load_dwordx4 v[204:207], v1, s[40:43], s72 offen offset:3072 nt
  s_waitcnt vmcnt(12)
  v_lshrrev_b32 v16, 16, v49
  v_and_b32 v17, s78, v49
  v_dot2c_f32_bf16 v6, v156, v16
  v_dot2c_f32_bf16 v7, v156, v17
  v_dot2c_f32_bf16 v8, v157, v16
  v_dot2c_f32_bf16 v9, v157, v17
  v_dot2c_f32_bf16 v10, v158, v16
  v_dot2c_f32_bf16 v11, v158, v17
  v_dot2c_f32_bf16 v12, v159, v16
  v_dot2c_f32_bf16 v13, v159, v17
  s_mov_b32 s72, 196608
  buffer_load_dwordx4 v[208:211], v1, s[40:43], s72 offen offset:0 nt
  s_waitcnt vmcnt(12)
  v_and_b32 v14, 0xffff, v50
  v_lshlrev_b32 v15, 16, v50
  v_dot2c_f32_bf16 v6, v160, v14
  v_dot2c_f32_bf16 v7, v160, v15
  v_dot2c_f32_bf16 v8, v161, v14
  v_dot2c_f32_bf16 v9, v161, v15
  v_dot2c_f32_bf16 v10, v162, v14
  v_dot2c_f32_bf16 v11, v162, v15
  v_dot2c_f32_bf16 v12, v163, v14
  v_dot2c_f32_bf16 v13, v163, v15
  buffer_load_dwordx4 v[212:215], v1, s[40:43], s72 offen offset:1024 nt
  s_waitcnt vmcnt(12)
  v_lshrrev_b32 v16, 16, v50
  v_and_b32 v17, s78, v50
  v_dot2c_f32_bf16 v6, v164, v16
  v_dot2c_f32_bf16 v7, v164, v17
  v_dot2c_f32_bf16 v8, v165, v16
  v_dot2c_f32_bf16 v9, v165, v17
  v_dot2c_f32_bf16 v10, v166, v16
  v_dot2c_f32_bf16 v11, v166, v17
  v_dot2c_f32_bf16 v12, v167, v16
  v_dot2c_f32_bf16 v13, v167, v17
  buffer_load_dwordx4 v[216:219], v1, s[40:43], s72 offen offset:2048 nt
  s_waitcnt vmcnt(12)
  v_and_b32 v14, 0xffff, v51
  v_lshlrev_b32 v15, 16, v51
  v_dot2c_f32_bf16 v6, v168, v14
  v_dot2c_f32_bf16 v7, v168, v15
  v_dot2c_f32_bf16 v8, v169, v14
  v_dot2c_f32_bf16 v9, v169, v15
  v_dot2c_f32_bf16 v10, v170, v14
  v_dot2c_f32_bf16 v11, v170, v15
  v_dot2c_f32_bf16 v12, v171, v14
  v_dot2c_f32_bf16 v13, v171, v15
  buffer_load_dwordx4 v[220:223], v1, s[40:43], s72 offen offset:3072 nt
  s_waitcnt vmcnt(12)
  v_lshrrev_b32 v16, 16, v51
  v_and_b32 v17, s78, v51
  v_dot2c_f32_bf16 v6, v172, v16
  v_dot2c_f32_bf16 v7, v172, v17
  v_dot2c_f32_bf16 v8, v173, v16
  v_dot2c_f32_bf16 v9, v173, v17
  v_dot2c_f32_bf16 v10, v174, v16
  v_dot2c_f32_bf16 v11, v174, v17
  v_dot2c_f32_bf16 v12, v175, v16
  v_dot2c_f32_bf16 v13, v175, v17
  s_mov_b32 s72, 212992
  buffer_load_dwordx4 v[224:227], v1, s[40:43], s72 offen offset:0 nt
  s_waitcnt vmcnt(12)
  v_and_b32 v14, 0xffff, v52
  v_lshlrev_b32 v15, 16, v52
  v_dot2c_f32_bf16 v6, v176, v14
  v_dot2c_f32_bf16 v7, v176, v15
  v_dot2c_f32_bf16 v8, v177, v14
  v_dot2c_f32_bf16 v9, v177, v15
  v_dot2c_f32_bf16 v10, v178, v14
  v_dot2c_f32_bf16 v11, v178, v15
  v_dot2c_f32_bf16 v12, v179, v14
  v_dot2c_f32_bf16 v13, v179, v15
  buffer_load_dwordx4 v[228:231], v1, s[40:43], s72 offen offset:1024 nt
  s_waitcnt vmcnt(12)
  v_lshrrev_b32 v16, 16, v52
  v_and_b32 v17, s78, v52
  v_dot2c_f32_bf16 v6, v180, v16
  v_dot2c_f32_bf16 v7, v180, v17
  v_dot2c_f32_bf16 v8, v181, v16
  v_dot2c_f32_bf16 v9, v181, v17
  v_dot2c_f32_bf16 v10, v182, v16
  v_dot2c_f32_bf16 v11, v182, v17
  v_dot2c_f32_bf16 v12, v183, v16
  v_dot2c_f32_bf16 v13, v183, v17
  buffer_load_dwordx4 v[232:235], v1, s[40:43], s72 offen offset:2048 nt
  s_waitcnt vmcnt(12)
  v_and_b32 v14, 0xffff, v53
  v_lshlrev_b32 v15, 16, v53
  v_dot2c_f32_bf16 v6, v184, v14
  v_dot2c_f32_bf16 v7, v184, v15
  v_dot2c_f32_bf16 v8, v185, v14
  v_dot2c_f32_bf16 v9, v185, v15
  v_dot2c_f32_bf16 v10, v186, v14
  v_dot2c_f32_bf16 v11, v186, v15
  v_dot2c_f32_bf16 v12, v187, v14
  v_dot2c_f32_bf16 v13, v187, v15
  buffer_load_dwordx4 v[236:239], v1, s[40:43], s72 offen offset:3072 nt
  s_waitcnt vmcnt(12)
  v_lshrrev_b32 v16, 16, v53
  v_and_b32 v17, s78, v53
  v_dot2c_f32_bf16 v6, v188, v16
  v_dot2c_f32_bf16 v7, v188, v17
  v_dot2c_f32_bf16 v8, v189, v16
  v_dot2c_f32_bf16 v9, v189, v17
  v_dot2c_f32_bf16 v10, v190, v16
  v_dot2c_f32_bf16 v11, v190, v17
  v_dot2c_f32_bf16 v12, v191, v16
  v_dot2c_f32_bf16 v13, v191, v17
  s_mov_b32 s72, 229376
  buffer_load_dwordx4 v[64:67], v1, s[40:43], s72 offen offset:0 nt
  s_waitcnt vmcnt(12)
  v_and_b32 v14, 0xffff, v54
  v_lshlrev_b32 v15, 16, v54
  v_dot2c_f32_bf16 v6, v192, v14
  v_dot2c_f32_bf16 v7, v192, v15
  v_dot2c_f32_bf16 v8, v193, v14
  v_dot2c_f32_bf16 v9, v193, v15
  v_dot2c_f32_bf16 v10, v194, v14
  v_dot2c_f32_bf16 v11, v194, v15
  v_dot2c_f32_bf16 v12, v195, v14
  v_dot2c_f32_bf16 v13, v195, v15
  buffer_load_dwordx4 v[68:71], v1, s[40:43], s72 offen offset:1024 nt
  s_waitcnt vmcnt(12)
  v_lshrrev_b32 v16, 16, v54
  v_and_b32 v17, s78, v54
  v_dot2c_f32_bf16 v6, v196, v16
  v_dot2c_f32_bf16 v7, v196, v17
  v_dot2c_f32_bf16 v8, v197, v16
  v_dot2c_f32_bf16 v9, v197, v17
  v_dot2c_f32_bf16 v10, v198, v16
  v_dot2c_f32_bf16 v11, v198, v17
  v_dot2c_f32_bf16 v12, v199, v16
  v_dot2c_f32_bf16 v13, v199, v17
  buffer_load_dwordx4 v[72:75], v1, s[40:43], s72 offen offset:2048 nt
  s_waitcnt vmcnt(12)
  v_and_b32 v14, 0xffff, v55
  v_lshlrev_b32 v15, 16, v55
  v_dot2c_f32_bf16 v6, v200, v14
  v_dot2c_f32_bf16 v7, v200, v15
  v_dot2c_f32_bf16 v8, v201, v14
  v_dot2c_f32_bf16 v9, v201, v15
  v_dot2c_f32_bf16 v10, v202, v14
  v_dot2c_f32_bf16 v11, v202, v15
  v_dot2c_f32_bf16 v12, v203, v14
  v_dot2c_f32_bf16 v13, v203, v15
  buffer_load_dwordx4 v[76:79], v1, s[40:43], s72 offen offset:3072 nt
  s_waitcnt vmcnt(12)
  v_lshrrev_b32 v16, 16, v55
  v_and_b32 v17, s78, v55
  v_dot2c_f32_bf16 v6, v204, v16
  v_dot2c_f32_bf16 v7, v204, v17
  v_dot2c_f32_bf16 v8, v205, v16
  v_dot2c_f32_bf16 v9, v205, v17
  v_dot2c_f32_bf16 v10, v206, v16
  v_dot2c_f32_bf16 v11, v206, v17
  v_dot2c_f32_bf16 v12, v207, v16
  v_dot2c_f32_bf16 v13, v207, v17
  s_mov_b32 s72, 245760
  buffer_load_dwordx4 v[80:83], v1, s[40:43], s72 offen offset:0 nt
  s_waitcnt vmcnt(12)
  v_and_b32 v14, 0xffff, v56
  v_lshlrev_b32 v15, 16, v56
  v_dot2c_f32_bf16 v6, v208, v14
  v_dot2c_f32_bf16 v7, v208, v15
  v_dot2c_f32_bf16 v8, v209, v14
  v_dot2c_f32_bf16 v9, v209, v15
  v_dot2c_f32_bf16 v10, v210, v14
  v_dot2c_f32_bf16 v11, v210, v15
  v_dot2c_f32_bf16 v12, v211, v14
  v_dot2c_f32_bf16 v13, v211, v15
  buffer_load_dwordx4 v[84:87], v1, s[40:43], s72 offen offset:1024 nt
  s_waitcnt vmcnt(12)
  v_lshrrev_b32 v16, 16, v56
  v_and_b32 v17, s78, v56
  v_dot2c_f32_bf16 v6, v212, v16
  v_dot2c_f32_bf16 v7, v212, v17
  v_dot2c_f32_bf16 v8, v213, v16
  v_dot2c_f32_bf16 v9, v213, v17
  v_dot2c_f32_bf16 v10, v214, v16
  v_dot2c_f32_bf16 v11, v214, v17
  v_dot2c_f32_bf16 v12, v215, v16
  v_dot2c_f32_bf16 v13, v215, v17
  buffer_load_dwordx4 v[88:91], v1, s[40:43], s72 offen offset:2048 nt
  s_waitcnt vmcnt(12)
  v_and_b32 v14, 0xffff, v57
  v_lshlrev_b32 v15, 16, v57
  v_dot2c_f32_bf16 v6, v216, v14
  v_dot2c_f32_bf16 v7, v216, v15
  v_dot2c_f32_bf16 v8, v217, v14
  v_dot2c_f32_bf16 v9, v217, v15
  v_dot2c_f32_bf16 v10, v218, v14
  v_dot2c_f32_bf16 v11, v218, v15
  v_dot2c_f32_bf16 v12, v219, v14
  v_dot2c_f32_bf16 v13, v219, v15
  buffer_load_dwordx4 v[92:95], v1, s[40:43], s72 offen offset:3072 nt
  s_waitcnt vmcnt(12)
  v_lshrrev_b32 v16, 16, v57
  v_and_b32 v17, s78, v57
  v_dot2c_f32_bf16 v6, v220, v16
  v_dot2c_f32_bf16 v7, v220, v17
  v_dot2c_f32_bf16 v8, v221, v16
  v_dot2c_f32_bf16 v9, v221, v17
  v_dot2c_f32_bf16 v10, v222, v16
  v_dot2c_f32_bf16 v11, v222, v17
  v_dot2c_f32_bf16 v12, v223, v16
  v_dot2c_f32_bf16 v13, v223, v17
  s_waitcnt vmcnt(11)
  v_and_b32 v14, 0xffff, v58
  v_lshlrev_b32 v15, 16, v58
  v_dot2c_f32_bf16 v6, v224, v14
  v_dot2c_f32_bf16 v7, v224, v15
  v_dot2c_f32_bf16 v8, v225, v14
  v_dot2c_f32_bf16 v9, v225, v15
  v_dot2c_f32_bf16 v10, v226, v14
  v_dot2c_f32_bf16 v11, v226, v15
  v_dot2c_f32_bf16 v12, v227, v14
  v_dot2c_f32_bf16 v13, v227, v15
  s_waitcnt vmcnt(10)
  v_lshrrev_b32 v16, 16, v58
  v_and_b32 v17, s78, v58
  v_dot2c_f32_bf16 v6, v228, v16
  v_dot2c_f32_bf16 v7, v228, v17
  v_dot2c_f32_bf16 v8, v229, v16
  v_dot2c_f32_bf16 v9, v229, v17
  v_dot2c_f32_bf16 v10, v230, v16
  v_dot2c_f32_bf16 v11, v230, v17
  v_dot2c_f32_bf16 v12, v231, v16
  v_dot2c_f32_bf16 v13, v231, v17
  s_waitcnt vmcnt(9)
  v_and_b32 v14, 0xffff, v59
  v_lshlrev_b32 v15, 16, v59
  v_dot2c_f32_bf16 v6, v232, v14
  v_dot2c_f32_bf16 v7, v232, v15
  v_dot2c_f32_bf16 v8, v233, v14
  v_dot2c_f32_bf16 v9, v233, v15
  v_dot2c_f32_bf16 v10, v234, v14
  v_dot2c_f32_bf16 v11, v234, v15
  v_dot2c_f32_bf16 v12, v235, v14
  v_dot2c_f32_bf16 v13, v235, v15
  s_waitcnt vmcnt(8)
  v_lshrrev_b32 v16, 16, v59
  v_and_b32 v17, s78, v59
  v_dot2c_f32_bf16 v6, v236, v16
  v_dot2c_f32_bf16 v7, v236, v17
  v_dot2c_f32_bf16 v8, v237, v16
  v_dot2c_f32_bf16 v9, v237, v17
  v_dot2c_f32_bf16 v10, v238, v16
  v_dot2c_f32_bf16 v11, v238, v17
  v_dot2c_f32_bf16 v12, v239, v16
  v_dot2c_f32_bf16 v13, v239, v17
  v_mov_b32 v22, 0
  ds_read_b96 v[18:20], v22 offset:12480
  s_waitcnt vmcnt(7)
  v_and_b32 v14, 0xffff, v60
  v_lshlrev_b32 v15, 16, v60
  v_dot2c_f32_bf16 v6, v64, v14
  v_dot2c_f32_bf16 v7, v64, v15
  v_dot2c_f32_bf16 v8, v65, v14
  v_dot2c_f32_bf16 v9, v65, v15
  v_dot2c_f32_bf16 v10, v66, v14
  v_dot2c_f32_bf16 v11, v66, v15
  v_dot2c_f32_bf16 v12, v67, v14
  v_dot2c_f32_bf16 v13, v67, v15
  s_waitcnt lgkmcnt(0)
  v_readfirstlane_b32 s5, v20
  v_sub_f32 v23, v24, v18
  v_mul_f32 v23, s77, v23
  v_exp_f32 v23, v23
  s_nop 0
  v_mul_f32 v23, v23, v19
  s_waitcnt vmcnt(6)
  v_lshrrev_b32 v16, 16, v60
  v_and_b32 v17, s78, v60
  v_dot2c_f32_bf16 v6, v68, v16
  v_dot2c_f32_bf16 v7, v68, v17
  v_dot2c_f32_bf16 v8, v69, v16
  v_dot2c_f32_bf16 v9, v69, v17
  v_dot2c_f32_bf16 v10, v70, v16
  v_dot2c_f32_bf16 v11, v70, v17
  v_dot2c_f32_bf16 v12, v71, v16
  v_dot2c_f32_bf16 v13, v71, v17
  s_waitcnt vmcnt(5)
  v_and_b32 v14, 0xffff, v61
  v_lshlrev_b32 v15, 16, v61
  v_dot2c_f32_bf16 v6, v72, v14
  v_dot2c_f32_bf16 v7, v72, v15
  v_dot2c_f32_bf16 v8, v73, v14
  v_dot2c_f32_bf16 v9, v73, v15
  v_dot2c_f32_bf16 v10, v74, v14
  v_dot2c_f32_bf16 v11, v74, v15
  v_dot2c_f32_bf16 v12, v75, v14
  v_dot2c_f32_bf16 v13, v75, v15
  s_waitcnt vmcnt(4)
  v_lshrrev_b32 v16, 16, v61
  v_and_b32 v17, s78, v61
  v_dot2c_f32_bf16 v6, v76, v16
  v_dot2c_f32_bf16 v7, v76, v17
  v_dot2c_f32_bf16 v8, v77, v16
  v_dot2c_f32_bf16 v9, v77, v17
  v_dot2c_f32_bf16 v10, v78, v16
  v_dot2c_f32_bf16 v11, v78, v17
  v_dot2c_f32_bf16 v12, v79, v16
  v_dot2c_f32_bf16 v13, v79, v17
  s_waitcnt vmcnt(3)
  v_and_b32 v14, 0xffff, v62
  v_lshlrev_b32 v15, 16, v62
  v_dot2c_f32_bf16 v6, v80, v14
  v_dot2c_f32_bf16 v7, v80, v15
  v_dot2c_f32_bf16 v8, v81, v14
  v_dot2c_f32_bf16 v9, v81, v15
  v_dot2c_f32_bf16 v10, v82, v14
  v_dot2c_f32_bf16 v11, v82, v15
  v_dot2c_f32_bf16 v12, v83, v14
  v_dot2c_f32_bf16 v13, v83, v15
  s_waitcnt vmcnt(2)
  v_lshrrev_b32 v16, 16, v62
  v_and_b32 v17, s78, v62
  v_dot2c_f32_bf16 v6, v84, v16
  v_dot2c_f32_bf16 v7, v84, v17
  v_dot2c_f32_bf16 v8, v85, v16
  v_dot2c_f32_bf16 v9, v85, v17
  v_dot2c_f32_bf16 v10, v86, v16
  v_dot2c_f32_bf16 v11, v86, v17
  v_dot2c_f32_bf16 v12, v87, v16
  v_dot2c_f32_bf16 v13, v87, v17
  s_waitcnt vmcnt(1)
  v_and_b32 v14, 0xffff, v63
  v_lshlrev_b32 v15, 16, v63
  v_dot2c_f32_bf16 v6, v88, v14
  v_dot2c_f32_bf16 v7, v88, v15
  v_dot2c_f32_bf16 v8, v89, v14
  v_dot2c_f32_bf16 v9, v89, v15
  v_dot2c_f32_bf16 v10, v90, v14
  v_dot2c_f32_bf16 v11, v90, v15
  v_dot2c_f32_bf16 v12, v91, v14
  v_dot2c_f32_bf16 v13, v91, v15
  s_waitcnt vmcnt(0)
  v_lshrrev_b32 v16, 16, v63
  v_and_b32 v17, s78, v63
  v_dot2c_f32_bf16 v6, v92, v16
  v_dot2c_f32_bf16 v7, v92, v17
  v_dot2c_f32_bf16 v8, v93, v16
  v_dot2c_f32_bf16 v9, v93, v17
  v_dot2c_f32_bf16 v10, v94, v16
  v_dot2c_f32_bf16 v11, v94, v17
  v_dot2c_f32_bf16 v12, v95, v16
  v_dot2c_f32_bf16 v13, v95, v17
  s_cmp_eq_u32 s5, 1
  s_cbranch_scc1 L_fok
  v_mov_b32 v22, 0
  s_mov_b32 s79, 0x400000
L_gwait:
  ds_read_b96 v[18:20], v22 offset:12480
  s_waitcnt lgkmcnt(0)
  v_readfirstlane_b32 s4, v20
  s_cmp_eq_u32 s4, 1
  s_cbranch_scc1 L_gok
  s_sub_u32 s79, s79, 1
  s_cmp_eq_u32 s79, 0
  s_cbranch_scc1 L_gok
  s_sleep 1
  s_branch L_gwait
L_gok:
  v_sub_f32 v23, v24, v18
  v_mul_f32 v23, s77, v23
  v_exp_f32 v23, v23
  s_nop 0
  v_mul_f32 v23, v23, v19
L_fok:
  s_nop 2
  v_mul_f32 v6, v6, v23
  v_mul_f32 v7, v7, v23
  v_mul_f32 v8, v8, v23
  v_mul_f32 v9, v9, v23
  v_mul_f32 v10, v10, v23
  v_mul_f32 v11, v11, v23
  v_mul_f32 v12, v12, v23
  v_mul_f32 v13, v13, v23
  s_nop 1
  v_permlane32_swap_b32 v6, v10
  v_permlane32_swap_b32 v7, v11
  v_permlane32_swap_b32 v8, v12
  v_permlane32_swap_b32 v9, v13
  s_nop 1
  v_add_f32 v6, v6, v10
  v_add_f32 v8, v8, v12
  v_add_f32 v7, v7, v11
  v_add_f32 v9, v9, v13
  s_nop 1
  v_permlane16_swap_b32 v6, v8
  v_permlane16_swap_b32 v7, v9
  s_nop 1
  v_add_f32 v6, v6, v8
  v_add_f32 v7, v7, v9
  ds_write_b32 v25, v6 offset:14336
  ds_write_b32 v25, v7 offset:14592
  s_mov_b64 exec, 1
  ds_add_u32 v26, v27 offset:12564
  s_mov_b64 exec, -1
  s_branch L_fin
L_B:
  s_load_dwordx16 s[8:23], s[0:1], 0
  s_load_dwordx4 s[24:27], s[0:1], 64
  s_load_dwordx2 s[28:29], s[0:1], 80
  s_setprio 3
  s_and_b32 s4, s2, 7
  s_lshr_b32 s5, s2, 3
  s_lshr_b32 s6, s5, 3
  s_and_b32 s35, s5, 7
  s_lshl_b32 s6, s6, 1
  s_add_u32 s6, s6, s32
  s_mul_i32 s7, s4, 43
  s_lshr_b32 s7, s7, 3
  s_add_u32 s5, s4, 1
  s_mul_i32 s5, s5, 43
  s_lshr_b32 s5, s5, 3
  s_add_u32 s33, s7, s6
  s_cmp_lt_u32 s33, s5
  s_cselect_b32 s33, s33, 63
  s_lshl_b32 s34, s30, 1
  s_add_u32 s34, s34, s32
  s_mov_b32 s76, 0x3db504f3
  s_mov_b32 s77, 0x3fb8aa3b
  s_mov_b32 s78, 0xffff0000
  s_sub_u32 s73, s3, 4
  v_lshrrev_b32 v44, 4, v0
  v_and_b32 v45, 15, v0
  v_lshlrev_b32 v2, 15, v44
  v_lshl_add_u32 v2, v45, 4, v2
  v_lshlrev_b32 v5, 10, v44
  v_lshl_add_u32 v5, v45, 4, v5
  v_and_b32 v46, 1, v44
  v_lshlrev_b32 v46, 2, v46
  v_lshrrev_b32 v47, 1, v44
  v_add_u32 v46, v46, v47
  v_lshlrev_b32 v4, 10, v46
  v_lshl_add_u32 v4, v45, 4, v4
  v_lshrrev_b32 v46, 5, v0
  v_lshlrev_b32 v7, 6, v45
  v_lshl_add_u32 v7, v46, 5, v7
  v_bfe_u32 v47, v0, 4, 1
  v_lshl_add_u32 v7, v47, 4, v7
  v_lshrrev_b32 v44, 2, v0
  v_mul_u32_u24 v3, 22016, v44
  v_and_b32 v45, 3, v0
  v_lshl_add_u32 v3, v45, 4, v3
  v_and_b32 v44, 3, v0
  v_lshlrev_b32 v44, 2, v44
  v_lshl_add_u32 v6, v46, 1, v44
  v_mov_b32 v52, 0
  v_mov_b32 v53, 0
  v_mov_b32 v54, 0
  v_mov_b32 v55, 0
  v_mov_b32 v56, -1
  v_mov_b32 v57, -1
  v_mov_b32 v58, -1
  v_mov_b32 v59, -1
  v_mov_b32 v8, 0
  v_mov_b32 v9, 0
  v_mov_b32 v10, 0
  v_mov_b32 v11, 0
  v_mov_b32 v12, 0
  v_mov_b32 v13, 0
  v_mov_b32 v14, 0
  v_mov_b32 v15, 0
  v_mov_b32 v16, 0
  v_mov_b32 v17, 0
  v_mov_b32 v18, 0
  v_mov_b32 v19, 0
  v_mov_b32 v20, 0
  v_mov_b32 v21, 0
  v_mov_b32 v22, 0
  v_mov_b32 v23, 0
  ds_write_b128 v1, v[52:55] offset:12288
  s_waitcnt lgkmcnt(0)
  s_add_u32 s40, s28, 0x2f0000
  s_addc_u32 s41, s29, 0
  s_load_dword s43, s[40:41], 0
  s_lshl_b32 s4, s31, 6
  s_add_u32 s4, s4, s34
  s_lshl_b32 s4, s4, 12
  s_lshl_b32 s5, s73, 10
  s_add_u32 s4, s4, s5
  s_add_u32 s62, s28, s4
  s_addc_u32 s63, s29, 0
  s_lshl_b32 s4, s2, 7
  s_add_u32 s4, s4, 0x100000
  s_add_u32 s66, s28, s4
  s_addc_u32 s67, s29, 0
  s_lshl_b32 s4, s30, 15
  s_add_u32 s4, s4, 0x180000
  s_add_u32 s36, s28, s4
  s_addc_u32 s37, s29, 0
  s_mov_b32 s38, 0x8000
  s_mov_b32 s39, 0x20000
  s_lshl_b32 s4, s35, 2
  s_add_u32 s4, s4, s73
  s_lshl_b32 s74, s4, 10
  s_lshl_b32 s4, s73, 10
  s_add_u32 s6, s8, s4
  s_addc_u32 s7, s9, 0
  global_load_dwordx4 v[24:27], v1, s[6:7]
  s_lshl_b32 s4, s35, 2
  s_add_u32 s4, s4, s73
  s_lshl_b32 s4, s4, 17
  s_lshl_b32 s5, s30, 8
  s_add_u32 s4, s4, s5
  s_add_u32 s44, s14, s4
  s_addc_u32 s45, s15, 0
  s_mov_b32 s46, 0x20000
  s_mov_b32 s47, 0x20000
  s_mov_b32 s72, 0
  buffer_load_dwordx4 v[64:67], v2, s[44:47], s72 offen
  s_mov_b32 s72, 8192
  buffer_load_dwordx4 v[68:71], v2, s[44:47], s72 offen
  s_mov_b32 s72, 16384
  buffer_load_dwordx4 v[72:75], v2, s[44:47], s72 offen
  s_mov_b32 s72, 24576
  buffer_load_dwordx4 v[76:79], v2, s[44:47], s72 offen
  s_barrier
  s_lshl_b32 s4, s31, 10
  s_add_u32 s60, s8, s4
  s_addc_u32 s61, s9, 0
  s_xor_b32 s4, s2, 8
  s_lshl_b32 s4, s4, 7
  s_add_u32 s4, s4, 0x100000
  s_add_u32 s68, s28, s4
  s_addc_u32 s69, s29, 0
  s_lshl_b32 s4, s34, 4
  s_lshl_b32 s5, s31, 10
  s_add_u32 s4, s4, s5
  s_add_u32 s70, s24, s4
  s_addc_u32 s71, s25, 0
  s_lshl_b32 s4, s30, 17
  s_lshl_b32 s5, s73, 8
  s_add_u32 s4, s4, s5
  s_add_u32 s48, s16, s4
  s_addc_u32 s49, s17, 0
  s_mov_b32 s50, 131072
  s_mov_b32 s51, 0x20000
  s_cmp_lt_u32 s33, 43
  s_cselect_b32 s75, 1, 0
  s_cselect_b32 s33, s33, 0
  s_cselect_b32 s54, 0x56000, 0
  s_cselect_b32 s58, 0x8000, 0
  s_lshl_b32 s4, s33, 6
  s_mul_i32 s5, s73, 352256
  s_add_u32 s4, s4, s5
  s_add_u32 s52, s20, s4
  s_addc_u32 s53, s21, 0
  s_mov_b32 s55, 0x20000
  s_lshl_b32 s4, s33, 15
  s_lshl_b32 s5, s73, 8
  s_add_u32 s4, s4, s5
  s_add_u32 s56, s22, s4
  s_addc_u32 s57, s23, 0
  s_mov_b32 s59, 0x20000
  s_lshl_b32 s4, s31, 18
  s_lshl_b32 s5, s34, 6
  s_add_u32 s4, s4, s5
  s_add_u32 s64, s28, s4
  s_addc_u32 s65, s29, 0
  s_waitcnt vmcnt(4)
  v_lshlrev_b32 v28, 16, v24
  v_and_b32 v29, s78, v24
  v_lshlrev_b32 v30, 16, v25
  v_and_b32 v31, s78, v25
  v_lshlrev_b32 v32, 16, v26
  v_and_b32 v33, s78, v26
  v_lshlrev_b32 v34, 16, v27
  v_and_b32 v35, s78, v27
  v_add_f32 v44, v28, v29
  v_add_f32 v45, v30, v31
  v_add_f32 v46, v32, v33
  v_add_f32 v47, v34, v35
  v_add_f32 v44, v44, v45
  v_add_f32 v46, v46, v47
  v_add_f32 v44, v44, v46
  s_nop 1
  v_add_f32_dpp v44, v44, v44 row_ror:8 row_mask:0xf bank_mask:0xf
  s_nop 1
  v_add_f32_dpp v44, v44, v44 row_ror:4 row_mask:0xf bank_mask:0xf
  s_nop 1
  v_add_f32_dpp v44, v44, v44 row_ror:2 row_mask:0xf bank_mask:0xf
  s_nop 1
  v_add_f32_dpp v44, v44, v44 row_ror:1 row_mask:0xf bank_mask:0xf
  v_mov_b32 v45, v44
  s_nop 1
  v_permlane16_swap_b32 v44, v45
  s_nop 1
  v_add_f32 v44, v44, v45
  v_mov_b32 v45, v44
  s_nop 1
  v_permlane32_swap_b32 v44, v45
  s_nop 1
  v_add_f32 v44, v44, v45
  v_mul_f32 v44, 0x3b000000, v44
  v_sub_f32 v48, v28, v44
  v_sub_f32 v49, v29, v44
  v_sub_f32 v50, v30, v44
  v_sub_f32 v51, v31, v44
  v_sub_f32 v52, v32, v44
  v_sub_f32 v53, v33, v44
  v_sub_f32 v54, v34, v44
  v_sub_f32 v55, v35, v44
  v_mul_f32 v46, v48, v48
  v_fmac_f32 v46, v49, v49
  v_fmac_f32 v46, v50, v50
  v_fmac_f32 v46, v51, v51
  v_fmac_f32 v46, v52, v52
  v_fmac_f32 v46, v53, v53
  v_fmac_f32 v46, v54, v54
  v_fmac_f32 v46, v55, v55
  s_nop 1
  v_add_f32_dpp v46, v46, v46 row_ror:8 row_mask:0xf bank_mask:0xf
  s_nop 1
  v_add_f32_dpp v46, v46, v46 row_ror:4 row_mask:0xf bank_mask:0xf
  s_nop 1
  v_add_f32_dpp v46, v46, v46 row_ror:2 row_mask:0xf bank_mask:0xf
  s_nop 1
  v_add_f32_dpp v46, v46, v46 row_ror:1 row_mask:0xf bank_mask:0xf
  v_mov_b32 v45, v46
  s_nop 1
  v_permlane16_swap_b32 v46, v45
  s_nop 1
  v_add_f32 v46, v46, v45
  v_mov_b32 v45, v46
  s_nop 1
  v_permlane32_swap_b32 v46, v45
  s_nop 1
  v_add_f32 v46, v46, v45
  v_mul_f32 v46, 0x3b000000, v46
  v_cvt_pk_bf16_f32 v45, v44, v46
  v_lshlrev_b32 v44, 16, v45
  v_and_b32 v46, s78, v45
  v_add_f32 v46, 0x3727c5ac, v46
  v_cvt_pk_bf16_f32 v46, v46, v46
  v_and_b32 v46, s78, v46
  v_sqrt_f32 v46, v46
  s_nop 0
  v_cvt_pk_bf16_f32 v46, v46, v46
  v_and_b32 v46, s78, v46
  v_rcp_f32 v47, v46
  v_sub_f32 v48, v28, v44
  v_sub_f32 v49, v29, v44
  v_cvt_pk_bf16_f32 v48, v48, v49
  v_and_b32 v49, s78, v48
  v_lshlrev_b32 v48, 16, v48
  v_mul_f32 v50, v48, v47
  v_mul_f32 v51, v49, v47
  v_fma_f32 v48, -v50, v46, v48
  v_fma_f32 v49, -v51, v46, v49
  v_fma_f32 v50, v48, v47, v50
  v_fma_f32 v51, v49, v47, v51
  v_cvt_pk_bf16_f32 v60, v50, v51
  v_sub_f32 v48, v30, v44
  v_sub_f32 v49, v31, v44
  v_cvt_pk_bf16_f32 v48, v48, v49
  v_and_b32 v49, s78, v48
  v_lshlrev_b32 v48, 16, v48
  v_mul_f32 v50, v48, v47
  v_mul_f32 v51, v49, v47
  v_fma_f32 v48, -v50, v46, v48
  v_fma_f32 v49, -v51, v46, v49
  v_fma_f32 v50, v48, v47, v50
  v_fma_f32 v51, v49, v47, v51
  v_cvt_pk_bf16_f32 v61, v50, v51
  v_sub_f32 v48, v32, v44
  v_sub_f32 v49, v33, v44
  v_cvt_pk_bf16_f32 v48, v48, v49
  v_and_b32 v49, s78, v48
  v_lshlrev_b32 v48, 16, v48
  v_mul_f32 v50, v48, v47
  v_mul_f32 v51, v49, v47
  v_fma_f32 v48, -v50, v46, v48
  v_fma_f32 v49, -v51, v46, v49
  v_fma_f32 v50, v48, v47, v50
  v_fma_f32 v51, v49, v47, v51
  v_cvt_pk_bf16_f32 v62, v50, v51
  v_sub_f32 v48, v34, v44
  v_sub_f32 v49, v35, v44
  v_cvt_pk_bf16_f32 v48, v48, v49
  v_and_b32 v49, s78, v48
  v_lshlrev_b32 v48, 16, v48
  v_mul_f32 v50, v48, v47
  v_mul_f32 v51, v49, v47
  v_fma_f32 v48, -v50, v46, v48
  v_fma_f32 v49, -v51, v46, v49
  v_fma_f32 v50, v48, v47, v50
  v_fma_f32 v51, v49, v47, v51
  v_cvt_pk_bf16_f32 v63, v50, v51
  s_lshl_b32 s4, s73, 10
  v_add_u32 v44, s4, v1
  ds_write_b128 v44, v[60:63] offset:0
  v_mov_b32 v45, 0
  v_mov_b32 v46, 1
  s_mov_b64 exec, 1
  ds_add_u32 v45, v46 offset:12544
  s_mov_b64 exec, -1
  v_mov_b32 v45, 0
  s_mov_b32 s79, 0x400000
L_spin3:
  ds_read_b32 v46, v45 offset:12544
  s_waitcnt lgkmcnt(0)
  v_readfirstlane_b32 s4, v46
  s_cmp_ge_u32 s4, 4
  s_cbranch_scc1 L_spun4
  s_sub_u32 s79, s79, 1
  s_cmp_eq_u32 s79, 0
  s_cbranch_scc1 L_spun4
  s_sleep 1
  s_branch L_spin3
L_spun4:
  s_lshl_b32 s4, s35, 2
  s_add_u32 s4, s4, s73
  s_lshl_b32 s4, s4, 5
  v_lshrrev_b32 v44, 4, v0
  v_lshlrev_b32 v44, 3, v44
  v_add_u32 v44, s4, v44
  ds_read_b64 v[24:25], v44 offset:0
  ds_read_b64 v[26:27], v44 offset:1024
  ds_read_b64 v[28:29], v44 offset:2048
  ds_read_b64 v[30:31], v44 offset:3072
  s_lshl_b32 s4, s73, 8
  s_lshl_b32 s5, s31, 10
  s_add_u32 s4, s4, s5
  v_lshrrev_b32 v45, 2, v0
  v_lshlrev_b32 v45, 4, v45
  v_add_u32 v45, s4, v45
  ds_read_b128 v[40:43], v45 offset:0
  v_mov_b32 v128, 0
  v_mov_b32 v129, 0
  v_mov_b32 v130, 0
  v_mov_b32 v131, 0
  v_mov_b32 v132, 0
  v_mov_b32 v133, 0
  v_mov_b32 v134, 0
  v_mov_b32 v135, 0
  v_mov_b32 v136, 0
  v_mov_b32 v137, 0
  v_mov_b32 v138, 0
  v_mov_b32 v139, 0
  v_mov_b32 v140, 0
  v_mov_b32 v141, 0
  v_mov_b32 v142, 0
  v_mov_b32 v143, 0
  v_mov_b32 v144, 0
  v_mov_b32 v145, 0
  v_mov_b32 v146, 0
  v_mov_b32 v147, 0
  v_mov_b32 v148, 0
  v_mov_b32 v149, 0
  v_mov_b32 v150, 0
  v_mov_b32 v151, 0
  v_mov_b32 v152, 0
  v_mov_b32 v153, 0
  v_mov_b32 v154, 0
  v_mov_b32 v155, 0
  v_mov_b32 v156, 0
  v_mov_b32 v157, 0
  v_mov_b32 v158, 0
  v_mov_b32 v159, 0
  s_waitcnt lgkmcnt(0)
  s_add_u32 s43, s43, 1
  s_waitcnt vmcnt(0)
  v_and_b32 v44, 0xffff, v24
  v_lshlrev_b32 v45, 16, v24
  v_dot2c_f32_bf16 v128, v64, v44
  v_dot2c_f32_bf16 v129, v64, v45
  v_dot2c_f32_bf16 v130, v65, v44
  v_dot2c_f32_bf16 v131, v65, v45
  v_dot2c_f32_bf16 v132, v66, v44
  v_dot2c_f32_bf16 v133, v66, v45
  v_dot2c_f32_bf16 v134, v67, v44
  v_dot2c_f32_bf16 v135, v67, v45
  v_and_b32 v46, 0xffff, v26
  v_lshlrev_b32 v47, 16, v26
  v_dot2c_f32_bf16 v136, v64, v46
  v_dot2c_f32_bf16 v137, v64, v47
  v_dot2c_f32_bf16 v138, v65, v46
  v_dot2c_f32_bf16 v139, v65, v47
  v_dot2c_f32_bf16 v140, v66, v46
  v_dot2c_f32_bf16 v141, v66, v47
  v_dot2c_f32_bf16 v142, v67, v46
  v_dot2c_f32_bf16 v143, v67, v47
  v_and_b32 v44, 0xffff, v28
  v_lshlrev_b32 v45, 16, v28
  v_dot2c_f32_bf16 v144, v64, v44
  v_dot2c_f32_bf16 v145, v64, v45
  v_dot2c_f32_bf16 v146, v65, v44
  v_dot2c_f32_bf16 v147, v65, v45
  v_dot2c_f32_bf16 v148, v66, v44
  v_dot2c_f32_bf16 v149, v66, v45
  v_dot2c_f32_bf16 v150, v67, v44
  v_dot2c_f32_bf16 v151, v67, v45
  v_and_b32 v46, 0xffff, v30
  v_lshlrev_b32 v47, 16, v30
  v_dot2c_f32_bf16 v152, v64, v46
  v_dot2c_f32_bf16 v153, v64, v47
  v_dot2c_f32_bf16 v154, v65, v46
  v_dot2c_f32_bf16 v155, v65, v47
  v_dot2c_f32_bf16 v156, v66, v46
  v_dot2c_f32_bf16 v157, v66, v47
  v_dot2c_f32_bf16 v158, v67, v46
  v_dot2c_f32_bf16 v159, v67, v47
  v_lshrrev_b32 v44, 16, v24
  v_and_b32 v45, s78, v24
  v_dot2c_f32_bf16 v128, v68, v44
  v_dot2c_f32_bf16 v129, v68, v45
  v_dot2c_f32_bf16 v130, v69, v44
  v_dot2c_f32_bf16 v131, v69, v45
  v_dot2c_f32_bf16 v132, v70, v44
  v_dot2c_f32_bf16 v133, v70, v45
  v_dot2c_f32_bf16 v134, v71, v44
  v_dot2c_f32_bf16 v135, v71, v45
  v_lshrrev_b32 v46, 16, v26
  v_and_b32 v47, s78, v26
  v_dot2c_f32_bf16 v136, v68, v46
  v_dot2c_f32_bf16 v137, v68, v47
  v_dot2c_f32_bf16 v138, v69, v46
  v_dot2c_f32_bf16 v139, v69, v47
  v_dot2c_f32_bf16 v140, v70, v46
  v_dot2c_f32_bf16 v141, v70, v47
  v_dot2c_f32_bf16 v142, v71, v46
  v_dot2c_f32_bf16 v143, v71, v47
  v_lshrrev_b32 v44, 16, v28
  v_and_b32 v45, s78, v28
  v_dot2c_f32_bf16 v144, v68, v44
  v_dot2c_f32_bf16 v145, v68, v45
  v_dot2c_f32_bf16 v146, v69, v44
  v_dot2c_f32_bf16 v147, v69, v45
  v_dot2c_f32_bf16 v148, v70, v44
  v_dot2c_f32_bf16 v149, v70, v45
  v_dot2c_f32_bf16 v150, v71, v44
  v_dot2c_f32_bf16 v151, v71, v45
  v_lshrrev_b32 v46, 16, v30
  v_and_b32 v47, s78, v30
  v_dot2c_f32_bf16 v152, v68, v46
  v_dot2c_f32_bf16 v153, v68, v47
  v_dot2c_f32_bf16 v154, v69, v46
  v_dot2c_f32_bf16 v155, v69, v47
  v_dot2c_f32_bf16 v156, v70, v46
  v_dot2c_f32_bf16 v157, v70, v47
  v_dot2c_f32_bf16 v158, v71, v46
  v_dot2c_f32_bf16 v159, v71, v47
  v_and_b32 v44, 0xffff, v25
  v_lshlrev_b32 v45, 16, v25
  v_dot2c_f32_bf16 v128, v72, v44
  v_dot2c_f32_bf16 v129, v72, v45
  v_dot2c_f32_bf16 v130, v73, v44
  v_dot2c_f32_bf16 v131, v73, v45
  v_dot2c_f32_bf16 v132, v74, v44
  v_dot2c_f32_bf16 v133, v74, v45
  v_dot2c_f32_bf16 v134, v75, v44
  v_dot2c_f32_bf16 v135, v75, v45
  v_and_b32 v46, 0xffff, v27
  v_lshlrev_b32 v47, 16, v27
  v_dot2c_f32_bf16 v136, v72, v46
  v_dot2c_f32_bf16 v137, v72, v47
  v_dot2c_f32_bf16 v138, v73, v46
  v_dot2c_f32_bf16 v139, v73, v47
  v_dot2c_f32_bf16 v140, v74, v46
  v_dot2c_f32_bf16 v141, v74, v47
  v_dot2c_f32_bf16 v142, v75, v46
  v_dot2c_f32_bf16 v143, v75, v47
  v_and_b32 v44, 0xffff, v29
  v_lshlrev_b32 v45, 16, v29
  v_dot2c_f32_bf16 v144, v72, v44
  v_dot2c_f32_bf16 v145, v72, v45
  v_dot2c_f32_bf16 v146, v73, v44
  v_dot2c_f32_bf16 v147, v73, v45
  v_dot2c_f32_bf16 v148, v74, v44
  v_dot2c_f32_bf16 v149, v74, v45
  v_dot2c_f32_bf16 v150, v75, v44
  v_dot2c_f32_bf16 v151, v75, v45
  v_and_b32 v46, 0xffff, v31
  v_lshlrev_b32 v47, 16, v31
  v_dot2c_f32_bf16 v152, v72, v46
  v_dot2c_f32_bf16 v153, v72, v47
  v_dot2c_f32_bf16 v154, v73, v46
  v_dot2c_f32_bf16 v155, v73, v47
  v_dot2c_f32_bf16 v156, v74, v46
  v_dot2c_f32_bf16 v157, v74, v47
  v_dot2c_f32_bf16 v158, v75, v46
  v_dot2c_f32_bf16 v159, v75, v47
  v_lshrrev_b32 v44, 16, v25
  v_and_b32 v45, s78, v25
  v_dot2c_f32_bf16 v128, v76, v44
  v_dot2c_f32_bf16 v129, v76, v45
  v_dot2c_f32_bf16 v130, v77, v44
  v_dot2c_f32_bf16 v131, v77, v45
  v_dot2c_f32_bf16 v132, v78, v44
  v_dot2c_f32_bf16 v133, v78, v45
  v_dot2c_f32_bf16 v134, v79, v44
  v_dot2c_f32_bf16 v135, v79, v45
  v_lshrrev_b32 v46, 16, v27
  v_and_b32 v47, s78, v27
  v_dot2c_f32_bf16 v136, v76, v46
  v_dot2c_f32_bf16 v137, v76, v47
  v_dot2c_f32_bf16 v138, v77, v46
  v_dot2c_f32_bf16 v139, v77, v47
  v_dot2c_f32_bf16 v140, v78, v46
  v_dot2c_f32_bf16 v141, v78, v47
  v_dot2c_f32_bf16 v142, v79, v46
  v_dot2c_f32_bf16 v143, v79, v47
  v_lshrrev_b32 v44, 16, v29
  v_and_b32 v45, s78, v29
  v_dot2c_f32_bf16 v144, v76, v44
  v_dot2c_f32_bf16 v145, v76, v45
  v_dot2c_f32_bf16 v146, v77, v44
  v_dot2c_f32_bf16 v147, v77, v45
  v_dot2c_f32_bf16 v148, v78, v44
  v_dot2c_f32_bf16 v149, v78, v45
  v_dot2c_f32_bf16 v150, v79, v44
  v_dot2c_f32_bf16 v151, v79, v45
  v_lshrrev_b32 v46, 16, v31
  v_and_b32 v47, s78, v31
  v_dot2c_f32_bf16 v152, v76, v46
  v_dot2c_f32_bf16 v153, v76, v47
  v_dot2c_f32_bf16 v154, v77, v46
  v_dot2c_f32_bf16 v155, v77, v47
  v_dot2c_f32_bf16 v156, v78, v46
  v_dot2c_f32_bf16 v157, v78, v47
  v_dot2c_f32_bf16 v158, v79, v46
  v_dot2c_f32_bf16 v159, v79, v47
  s_nop 2
  s_nop 0
  v_permlane32_swap_b32 v128, v132
  v_permlane32_swap_b32 v129, v133
  v_permlane32_swap_b32 v130, v134
  v_permlane32_swap_b32 v131, v135
  s_nop 1
  v_add_f32 v128, v128, v132
  v_add_f32 v130, v130, v134
  v_add_f32 v129, v129, v133
  v_add_f32 v131, v131, v135
  s_nop 1
  v_permlane16_swap_b32 v128, v130
  v_permlane16_swap_b32 v129, v131
  s_nop 1
  v_add_f32 v128, v128, v130
  v_add_f32 v129, v129, v131
  s_nop 0
  v_permlane32_swap_b32 v136, v140
  v_permlane32_swap_b32 v137, v141
  v_permlane32_swap_b32 v138, v142
  v_permlane32_swap_b32 v139, v143
  s_nop 1
  v_add_f32 v136, v136, v140
  v_add_f32 v138, v138, v142
  v_add_f32 v137, v137, v141
  v_add_f32 v139, v139, v143
  s_nop 1
  v_permlane16_swap_b32 v136, v138
  v_permlane16_swap_b32 v137, v139
  s_nop 1
  v_add_f32 v136, v136, v138
  v_add_f32 v137, v137, v139
  s_nop 0
  v_permlane32_swap_b32 v144, v148
  v_permlane32_swap_b32 v145, v149
  v_permlane32_swap_b32 v146, v150
  v_permlane32_swap_b32 v147, v151
  s_nop 1
  v_add_f32 v144, v144, v148
  v_add_f32 v146, v146, v150
  v_add_f32 v145, v145, v149
  v_add_f32 v147, v147, v151
  s_nop 1
  v_permlane16_swap_b32 v144, v146
  v_permlane16_swap_b32 v145, v147
  s_nop 1
  v_add_f32 v144, v144, v146
  v_add_f32 v145, v145, v147
  s_nop 0
  v_permlane32_swap_b32 v152, v156
  v_permlane32_swap_b32 v153, v157
  v_permlane32_swap_b32 v154, v158
  v_permlane32_swap_b32 v155, v159
  s_nop 1
  v_add_f32 v152, v152, v156
  v_add_f32 v154, v154, v158
  v_add_f32 v153, v153, v157
  v_add_f32 v155, v155, v159
  s_nop 1
  v_permlane16_swap_b32 v152, v154
  v_permlane16_swap_b32 v153, v155
  s_nop 1
  v_add_f32 v152, v152, v154
  v_add_f32 v153, v153, v155
  v_and_b32 v44, 15, v0
  v_lshlrev_b32 v44, 5, v44
  v_lshrrev_b32 v45, 5, v0
  v_lshl_add_u32 v44, v45, 4, v44
  v_bfe_u32 v46, v0, 4, 1
  v_lshl_add_u32 v44, v46, 3, v44
  s_lshl_b32 s4, s73, 11
  v_add_u32 v44, s4, v44
  ds_write_b64 v44, v[128:129] offset:4096
  ds_write_b64 v44, v[136:137] offset:4608
  ds_write_b64 v44, v[144:145] offset:5120
  ds_write_b64 v44, v[152:153] offset:5632
  v_mov_b32 v45, 0
  v_mov_b32 v46, 1
  s_mov_b64 exec, 1
  ds_add_u32 v45, v46 offset:12548
  s_mov_b64 exec, -1
  s_mov_b32 s72, 0
  buffer_load_dwordx4 v[64:67], v3, s[52:55], s72 offen
  s_mov_b32 s72, 2752
  buffer_load_dwordx4 v[68:71], v3, s[52:55], s72 offen
  v_mov_b32 v45, 0
  s_mov_b32 s79, 0x400000
L_spin5:
  ds_read_b32 v46, v45 offset:12548
  s_waitcnt lgkmcnt(0)
  v_readfirstlane_b32 s4, v46
  s_cmp_ge_u32 s4, 4
  s_cbranch_scc1 L_spun6
  s_sub_u32 s79, s79, 1
  s_cmp_eq_u32 s79, 0
  s_cbranch_scc1 L_spun6
  s_sleep 1
  s_branch L_spin5
L_spun6:
  s_lshl_b32 s5, s73, 9
  v_lshlrev_b32 v44, 3, v0
  v_add_u32 v44, s5, v44
  ds_read_b64 v[28:29], v44 offset:4096
  ds_read_b64 v[30:31], v44 offset:6144
  ds_read_b64 v[32:33], v44 offset:8192
  ds_read_b64 v[34:35], v44 offset:10240
  v_mov_b32 v25, s43
  v_mov_b32 v27, s43
  s_waitcnt lgkmcnt(0)
  v_add_f32 v28, v28, v30
  v_add_f32 v29, v29, v31
  v_add_f32 v32, v32, v34
  v_add_f32 v33, v33, v35
  v_add_f32 v24, v28, v32
  v_add_f32 v26, v29, v33
  buffer_store_dwordx4 v[24:27], v1, s[36:39], s74 offen sc1
  v_mov_b32 v8, 0
  v_mov_b32 v9, 0
  v_mov_b32 v10, 0
  v_mov_b32 v11, 0
  v_mov_b32 v12, 0
  v_mov_b32 v13, 0
  v_mov_b32 v14, 0
  v_mov_b32 v15, 0
  s_lshl_b32 s4, s34, 4
  s_add_u32 s6, s60, s4
  s_addc_u32 s7, s61, 0
  global_load_ushort v6, v6, s[6:7]
  s_mov_b32 s72, 5504
  buffer_load_dwordx4 v[72:75], v3, s[52:55], s72 offen
  s_waitcnt vmcnt(2)
  s_mov_b32 s72, 8256
  buffer_load_dwordx4 v[76:79], v3, s[52:55], s72 offen
  s_waitcnt vmcnt(2)
  s_mov_b32 s72, 11008
  buffer_load_dwordx4 v[80:83], v3, s[52:55], s72 offen
  s_waitcnt vmcnt(2)
  s_cmp_eq_u32 s73, 0
  s_cbranch_scc0 L_nogata
  s_mov_b32 s79, 0x20000
  s_mov_b64 s[84:85], -1
  s_mov_b64 s[86:87], -1
  s_mov_b64 s[88:89], -1
  s_mov_b64 s[90:91], -1
  s_mov_b64 s[92:93], -1
  s_mov_b64 s[94:95], -1
  s_mov_b64 s[96:97], -1
  s_mov_b64 s[98:99], -1
L_qpolla:
  s_mov_b64 exec, s[84:85]
  s_cbranch_execz L_qskipa0
  s_lshl_b32 s4, s31, 10
  s_add_u32 s72, s4, 0
  buffer_load_dwordx4 v[224:227], v1, s[36:39], s72 offen sc1
L_qskipa0:
  s_mov_b64 exec, s[86:87]
  s_cbranch_execz L_qskipa1
  s_lshl_b32 s4, s31, 10
  s_add_u32 s72, s4, 4096
  buffer_load_dwordx4 v[228:231], v1, s[36:39], s72 offen sc1
L_qskipa1:
  s_mov_b64 exec, s[88:89]
  s_cbranch_execz L_qskipa2
  s_lshl_b32 s4, s31, 10
  s_add_u32 s72, s4, 8192
  buffer_load_dwordx4 v[232:235], v1, s[36:39], s72 offen sc1
L_qskipa2:
  s_mov_b64 exec, s[90:91]
  s_cbranch_execz L_qskipa3
  s_lshl_b32 s4, s31, 10
  s_add_u32 s72, s4, 12288
  buffer_load_dwordx4 v[236:239], v1, s[36:39], s72 offen sc1
L_qskipa3:
  s_mov_b64 exec, s[92:93]
  s_cbranch_execz L_qskipa4
  s_lshl_b32 s4, s31, 10
  s_add_u32 s72, s4, 16384
  buffer_load_dwordx4 v[240:243], v1, s[36:39], s72 offen sc1
L_qskipa4:
  s_mov_b64 exec, s[94:95]
  s_cbranch_execz L_qskipa5
  s_lshl_b32 s4, s31, 10
  s_add_u32 s72, s4, 20480
  buffer_load_dwordx4 v[244:247], v1, s[36:39], s72 offen sc1
L_qskipa5:
  s_mov_b64 exec, s[96:97]
  s_cbranch_execz L_qskipa6
  s_lshl_b32 s4, s31, 10
  s_add_u32 s72, s4, 24576
  buffer_load_dwordx4 v[248:251], v1, s[36:39], s72 offen sc1
L_qskipa6:
  s_mov_b64 exec, s[98:99]
  s_cbranch_execz L_qskipa7
  s_lshl_b32 s4, s31, 10
  s_add_u32 s72, s4, 28672
  buffer_load_dwordx4 v[252:255], v1, s[36:39], s72 offen sc1
L_qskipa7:
  s_mov_b64 exec, -1
  s_waitcnt vmcnt(0)
  v_xor_b32 v45, s43, v225
  v_xor_b32 v46, s43, v227
  v_or_b32 v45, v45, v46
  v_cmp_ne_u32 s[84:85], 0, v45
  v_xor_b32 v45, s43, v229
  v_xor_b32 v46, s43, v231
  v_or_b32 v45, v45, v46
  v_cmp_ne_u32 s[86:87], 0, v45
  v_xor_b32 v45, s43, v233
  v_xor_b32 v46, s43, v235
  v_or_b32 v45, v45, v46
  v_cmp_ne_u32 s[88:89], 0, v45
  v_xor_b32 v45, s43, v237
  v_xor_b32 v46, s43, v239
  v_or_b32 v45, v45, v46
  v_cmp_ne_u32 s[90:91], 0, v45
  v_xor_b32 v45, s43, v241
  v_xor_b32 v46, s43, v243
  v_or_b32 v45, v45, v46
  v_cmp_ne_u32 s[92:93], 0, v45
  v_xor_b32 v45, s43, v245
  v_xor_b32 v46, s43, v247
  v_or_b32 v45, v45, v46
  v_cmp_ne_u32 s[94:95], 0, v45
  v_xor_b32 v45, s43, v249
  v_xor_b32 v46, s43, v251
  v_or_b32 v45, v45, v46
  v_cmp_ne_u32 s[96:97], 0, v45
  v_xor_b32 v45, s43, v253
  v_xor_b32 v46, s43, v255
  v_or_b32 v45, v45, v46
  v_cmp_ne_u32 s[98:99], 0, v45
  s_nop 1
  s_or_b64 s[4:5], s[84:85], s[86:87]
  s_or_b64 s[4:5], s[4:5], s[88:89]
  s_or_b64 s[4:5], s[4:5], s[90:91]
  s_or_b64 s[4:5], s[4:5], s[92:93]
  s_or_b64 s[4:5], s[4:5], s[94:95]
  s_or_b64 s[4:5], s[4:5], s[96:97]
  s_or_b64 s[4:5], s[4:5], s[98:99]
  s_cbranch_scc0 L_qoka
  s_sub_u32 s79, s79, 1
  s_cmp_eq_u32 s79, 0
  s_cbranch_scc1 L_qoka
  s_sleep 8
  s_branch L_qpolla
L_qoka:
  v_add_f32 v224, v224, v228
  v_add_f32 v226, v226, v230
  v_add_f32 v224, v224, v232
  v_add_f32 v226, v226, v234
  v_add_f32 v224, v224, v236
  v_add_f32 v226, v226, v238
  v_add_f32 v224, v224, v240
  v_add_f32 v226, v226, v242
  v_add_f32 v224, v224, v244
  v_add_f32 v226, v226, v246
  v_add_f32 v224, v224, v248
  v_add_f32 v226, v226, v250
  v_add_f32 v224, v224, v252
  v_add_f32 v226, v226, v254
  v_cvt_pk_bf16_f32 v44, v224, v226
  v_lshlrev_b32 v45, 2, v0
  ds_write_b32 v45, v44 offset:13312
  v_mov_b32 v45, 0
  v_mov_b32 v46, 1
  s_mov_b64 exec, 1
  ds_add_u32 v45, v46 offset:12552
  s_mov_b64 exec, -1
L_nogata:
  s_mov_b32 s72, 13760
  buffer_load_dwordx4 v[84:87], v3, s[52:55], s72 offen
  s_waitcnt vmcnt(2)
  s_mov_b32 s72, 16512
  buffer_load_dwordx4 v[88:91], v3, s[52:55], s72 offen
  s_waitcnt vmcnt(2)
  s_mov_b32 s72, 19264
  buffer_load_dwordx4 v[92:95], v3, s[52:55], s72 offen
  s_waitcnt vmcnt(2)
  s_mov_b32 s72, 0
  buffer_load_dwordx4 v[96:99], v5, s[56:59], s72 offen
  s_waitcnt vmcnt(2)
  s_mov_b32 s72, 4096
  buffer_load_dwordx4 v[100:103], v5, s[56:59], s72 offen
  s_waitcnt vmcnt(2)
  s_waitcnt vmcnt(2)
  v_and_b32 v44, 0xffff, v40
  v_lshlrev_b32 v45, 16, v40
  v_dot2c_f32_bf16 v16, v64, v44
  v_dot2c_f32_bf16 v17, v64, v45
  v_dot2c_f32_bf16 v18, v65, v44
  v_dot2c_f32_bf16 v19, v65, v45
  v_dot2c_f32_bf16 v20, v66, v44
  v_dot2c_f32_bf16 v21, v66, v45
  v_dot2c_f32_bf16 v22, v67, v44
  v_dot2c_f32_bf16 v23, v67, v45
  v_lshrrev_b32 v46, 16, v40
  v_and_b32 v47, s78, v40
  v_dot2c_f32_bf16 v16, v68, v46
  v_dot2c_f32_bf16 v17, v68, v47
  v_dot2c_f32_bf16 v18, v69, v46
  v_dot2c_f32_bf16 v19, v69, v47
  v_dot2c_f32_bf16 v20, v70, v46
  v_dot2c_f32_bf16 v21, v70, v47
  v_dot2c_f32_bf16 v22, v71, v46
  v_dot2c_f32_bf16 v23, v71, v47
  v_and_b32 v44, 0xffff, v41
  v_lshlrev_b32 v45, 16, v41
  v_dot2c_f32_bf16 v16, v72, v44
  v_dot2c_f32_bf16 v17, v72, v45
  v_dot2c_f32_bf16 v18, v73, v44
  v_dot2c_f32_bf16 v19, v73, v45
  v_dot2c_f32_bf16 v20, v74, v44
  v_dot2c_f32_bf16 v21, v74, v45
  v_dot2c_f32_bf16 v22, v75, v44
  v_dot2c_f32_bf16 v23, v75, v45
  v_lshrrev_b32 v46, 16, v41
  v_and_b32 v47, s78, v41
  v_dot2c_f32_bf16 v16, v76, v46
  v_dot2c_f32_bf16 v17, v76, v47
  v_dot2c_f32_bf16 v18, v77, v46
  v_dot2c_f32_bf16 v19, v77, v47
  v_dot2c_f32_bf16 v20, v78, v46
  v_dot2c_f32_bf16 v21, v78, v47
  v_dot2c_f32_bf16 v22, v79, v46
  v_dot2c_f32_bf16 v23, v79, v47
  v_and_b32 v44, 0xffff, v42
  v_lshlrev_b32 v45, 16, v42
  v_dot2c_f32_bf16 v16, v80, v44
  v_dot2c_f32_bf16 v17, v80, v45
  v_dot2c_f32_bf16 v18, v81, v44
  v_dot2c_f32_bf16 v19, v81, v45
  v_dot2c_f32_bf16 v20, v82, v44
  v_dot2c_f32_bf16 v21, v82, v45
  v_dot2c_f32_bf16 v22, v83, v44
  v_dot2c_f32_bf16 v23, v83, v45
  v_lshrrev_b32 v46, 16, v42
  v_and_b32 v47, s78, v42
  v_dot2c_f32_bf16 v16, v84, v46
  v_dot2c_f32_bf16 v17, v84, v47
  v_dot2c_f32_bf16 v18, v85, v46
  v_dot2c_f32_bf16 v19, v85, v47
  v_dot2c_f32_bf16 v20, v86, v46
  v_dot2c_f32_bf16 v21, v86, v47
  v_dot2c_f32_bf16 v22, v87, v46
  v_dot2c_f32_bf16 v23, v87, v47
  v_and_b32 v44, 0xffff, v43
  v_lshlrev_b32 v45, 16, v43
  v_dot2c_f32_bf16 v16, v88, v44
  v_dot2c_f32_bf16 v17, v88, v45
  v_dot2c_f32_bf16 v18, v89, v44
  v_dot2c_f32_bf16 v19, v89, v45
  v_dot2c_f32_bf16 v20, v90, v44
  v_dot2c_f32_bf16 v21, v90, v45
  v_dot2c_f32_bf16 v22, v91, v44
  v_dot2c_f32_bf16 v23, v91, v45
  v_lshrrev_b32 v46, 16, v43
  v_and_b32 v47, s78, v43
  v_dot2c_f32_bf16 v16, v92, v46
  v_dot2c_f32_bf16 v17, v92, v47
  v_dot2c_f32_bf16 v18, v93, v46
  v_dot2c_f32_bf16 v19, v93, v47
  v_dot2c_f32_bf16 v20, v94, v46
  v_dot2c_f32_bf16 v21, v94, v47
  v_dot2c_f32_bf16 v22, v95, v46
  v_dot2c_f32_bf16 v23, v95, v47
  s_nop 3
  v_permlane32_swap_b32 v16, v20
  v_permlane32_swap_b32 v17, v21
  v_permlane32_swap_b32 v18, v22
  v_permlane32_swap_b32 v19, v23
  s_nop 1
  v_add_f32 v16, v16, v20
  v_add_f32 v18, v18, v22
  v_add_f32 v17, v17, v21
  v_add_f32 v19, v19, v23
  s_nop 1
  v_permlane16_swap_b32 v16, v18
  v_permlane16_swap_b32 v17, v19
  s_nop 1
  v_add_f32 v16, v16, v18
  v_add_f32 v17, v17, v19
  s_nop 1
  v_add_f32_dpp v16, v16, v16 row_ror:8 row_mask:0xf bank_mask:0xf
  v_add_f32_dpp v17, v17, v17 row_ror:8 row_mask:0xf bank_mask:0xf
  s_nop 1
  v_add_f32_dpp v16, v16, v16 row_ror:4 row_mask:0xf bank_mask:0xf
  v_add_f32_dpp v17, v17, v17 row_ror:4 row_mask:0xf bank_mask:0xf
  v_and_b32 v47, 3, v0
  v_lshlrev_b32 v47, 3, v47
  v_lshrrev_b32 v45, 5, v0
  v_lshl_add_u32 v47, v45, 2, v47
  v_bfe_u32 v46, v0, 4, 1
  v_lshl_add_u32 v47, v46, 6, v47
  s_mov_b32 exec_lo, 0x000f000f
  s_mov_b32 exec_hi, 0x000f000f
  ds_add_f32 v47, v16 offset:12288
  ds_add_f32 v47, v17 offset:12320
  s_mov_b64 exec, -1
  v_mov_b32 v45, 0
  v_mov_b32 v46, 1
  s_mov_b64 exec, 1
  ds_add_u32 v45, v46 offset:12556
  s_mov_b64 exec, -1
  s_mov_b32 s72, 8192
  buffer_load_dwordx4 v[104:107], v5, s[56:59], s72 offen
  s_waitcnt vmcnt(2)
  s_mov_b32 s72, 12288
  buffer_load_dwordx4 v[108:111], v5, s[56:59], s72 offen
  s_waitcnt vmcnt(2)
  s_mov_b32 s72, 16384
  buffer_load_dwordx4 v[112:115], v5, s[56:59], s72 offen
  s_waitcnt vmcnt(2)
  s_mov_b32 s72, 20480
  buffer_load_dwordx4 v[116:119], v5, s[56:59], s72 offen
  s_waitcnt vmcnt(2)
  s_mov_b32 s72, 24576
  buffer_load_dwordx4 v[120:123], v5, s[56:59], s72 offen
  s_waitcnt vmcnt(2)
  s_mov_b32 s72, 28672
  buffer_load_dwordx4 v[124:127], v5, s[56:59], s72 offen
  s_waitcnt vmcnt(2)
  s_mov_b32 s72, 0
  buffer_load_dwordx4 v[128:131], v4, s[48:51], s72 offen
  s_waitcnt vmcnt(2)
  s_mov_b32 s72, 8192
  buffer_load_dwordx4 v[132:135], v4, s[48:51], s72 offen
  s_waitcnt vmcnt(2)
  v_mov_b32 v45, 0
  s_mov_b32 s79, 0x400000
L_spin7:
  ds_read_b32 v46, v45 offset:12556
  s_waitcnt lgkmcnt(0)
  v_readfirstlane_b32 s4, v46
  s_cmp_ge_u32 s4, 4
  s_cbranch_scc1 L_spun8
  s_sub_u32 s79, s79, 1
  s_cmp_eq_u32 s79, 0
  s_cbranch_scc1 L_spun8
  s_sleep 2
  s_branch L_spin7
L_spun8:
  v_lshrrev_b32 v45, 4, v0
  v_lshlrev_b32 v45, 5, v45
  ds_read_b128 v[24:27], v45 offset:12288
  ds_read_b128 v[28:31], v45 offset:12304
  s_waitcnt lgkmcnt(0)
  v_cvt_pk_bf16_f32 v32, v24, v25
  v_cvt_pk_bf16_f32 v33, v26, v27
  v_cvt_pk_bf16_f32 v34, v28, v29
  v_cvt_pk_bf16_f32 v35, v30, v31
  v_lshlrev_b32 v24, 16, v32
  v_and_b32 v25, s78, v32
  v_lshlrev_b32 v26, 16, v33
  v_and_b32 v27, s78, v33
  v_lshlrev_b32 v28, 16, v34
  v_and_b32 v29, s78, v34
  v_lshlrev_b32 v30, 16, v35
  v_and_b32 v31, s78, v35
  v_mul_f32 v32, 0xbfb8aa3b, v24
  v_mul_f32 v33, 0xbfb8aa3b, v25
  v_mul_f32 v34, 0xbfb8aa3b, v26
  v_mul_f32 v35, 0xbfb8aa3b, v27
  v_mul_f32 v36, 0xbfb8aa3b, v28
  v_mul_f32 v37, 0xbfb8aa3b, v29
  v_mul_f32 v38, 0xbfb8aa3b, v30
  v_mul_f32 v39, 0xbfb8aa3b, v31
  v_exp_f32 v32, v32
  v_exp_f32 v33, v33
  v_exp_f32 v34, v34
  v_exp_f32 v35, v35
  v_exp_f32 v36, v36
  v_exp_f32 v37, v37
  v_exp_f32 v38, v38
  v_exp_f32 v39, v39
  s_nop 0
  v_add_f32 v32, 1.0, v32
  v_add_f32 v33, 1.0, v33
  v_add_f32 v34, 1.0, v34
  v_add_f32 v35, 1.0, v35
  v_add_f32 v36, 1.0, v36
  v_add_f32 v37, 1.0, v37
  v_add_f32 v38, 1.0, v38
  v_add_f32 v39, 1.0, v39
  v_rcp_f32 v32, v32
  v_rcp_f32 v33, v33
  v_rcp_f32 v34, v34
  v_rcp_f32 v35, v35
  v_rcp_f32 v36, v36
  v_rcp_f32 v37, v37
  v_rcp_f32 v38, v38
  v_rcp_f32 v39, v39
  s_nop 0
  v_mul_f32 v32, v24, v32
  v_mul_f32 v33, v25, v33
  v_mul_f32 v34, v26, v34
  v_mul_f32 v35, v27, v35
  v_mul_f32 v36, v28, v36
  v_mul_f32 v37, v29, v37
  v_mul_f32 v38, v30, v38
  v_mul_f32 v39, v31, v39
  s_waitcnt vmcnt(2)
  v_cvt_pk_bf16_f32 v44, v32, 0
  v_cvt_pk_bf16_f32 v45, 0, v32
  v_dot2c_f32_bf16 v8, v96, v44
  v_dot2c_f32_bf16 v9, v96, v45
  v_dot2c_f32_bf16 v10, v97, v44
  v_dot2c_f32_bf16 v11, v97, v45
  v_dot2c_f32_bf16 v12, v98, v44
  v_dot2c_f32_bf16 v13, v98, v45
  v_dot2c_f32_bf16 v14, v99, v44
  v_dot2c_f32_bf16 v15, v99, v45
  v_cvt_pk_bf16_f32 v46, v33, 0
  v_cvt_pk_bf16_f32 v47, 0, v33
  v_dot2c_f32_bf16 v8, v100, v46
  v_dot2c_f32_bf16 v9, v100, v47
  v_dot2c_f32_bf16 v10, v101, v46
  v_dot2c_f32_bf16 v11, v101, v47
  v_dot2c_f32_bf16 v12, v102, v46
  v_dot2c_f32_bf16 v13, v102, v47
  v_dot2c_f32_bf16 v14, v103, v46
  v_dot2c_f32_bf16 v15, v103, v47
  v_cvt_pk_bf16_f32 v44, v34, 0
  v_cvt_pk_bf16_f32 v45, 0, v34
  v_dot2c_f32_bf16 v8, v104, v44
  v_dot2c_f32_bf16 v9, v104, v45
  v_dot2c_f32_bf16 v10, v105, v44
  v_dot2c_f32_bf16 v11, v105, v45
  v_dot2c_f32_bf16 v12, v106, v44
  v_dot2c_f32_bf16 v13, v106, v45
  v_dot2c_f32_bf16 v14, v107, v44
  v_dot2c_f32_bf16 v15, v107, v45
  v_cvt_pk_bf16_f32 v46, v35, 0
  v_cvt_pk_bf16_f32 v47, 0, v35
  v_dot2c_f32_bf16 v8, v108, v46
  v_dot2c_f32_bf16 v9, v108, v47
  v_dot2c_f32_bf16 v10, v109, v46
  v_dot2c_f32_bf16 v11, v109, v47
  v_dot2c_f32_bf16 v12, v110, v46
  v_dot2c_f32_bf16 v13, v110, v47
  v_dot2c_f32_bf16 v14, v111, v46
  v_dot2c_f32_bf16 v15, v111, v47
  v_cvt_pk_bf16_f32 v44, v36, 0
  v_cvt_pk_bf16_f32 v45, 0, v36
  v_dot2c_f32_bf16 v8, v112, v44
  v_dot2c_f32_bf16 v9, v112, v45
  v_dot2c_f32_bf16 v10, v113, v44
  v_dot2c_f32_bf16 v11, v113, v45
  v_dot2c_f32_bf16 v12, v114, v44
  v_dot2c_f32_bf16 v13, v114, v45
  v_dot2c_f32_bf16 v14, v115, v44
  v_dot2c_f32_bf16 v15, v115, v45
  v_cvt_pk_bf16_f32 v46, v37, 0
  v_cvt_pk_bf16_f32 v47, 0, v37
  v_dot2c_f32_bf16 v8, v116, v46
  v_dot2c_f32_bf16 v9, v116, v47
  v_dot2c_f32_bf16 v10, v117, v46
  v_dot2c_f32_bf16 v11, v117, v47
  v_dot2c_f32_bf16 v12, v118, v46
  v_dot2c_f32_bf16 v13, v118, v47
  v_dot2c_f32_bf16 v14, v119, v46
  v_dot2c_f32_bf16 v15, v119, v47
  v_cvt_pk_bf16_f32 v44, v38, 0
  v_cvt_pk_bf16_f32 v45, 0, v38
  v_dot2c_f32_bf16 v8, v120, v44
  v_dot2c_f32_bf16 v9, v120, v45
  v_dot2c_f32_bf16 v10, v121, v44
  v_dot2c_f32_bf16 v11, v121, v45
  v_dot2c_f32_bf16 v12, v122, v44
  v_dot2c_f32_bf16 v13, v122, v45
  v_dot2c_f32_bf16 v14, v123, v44
  v_dot2c_f32_bf16 v15, v123, v45
  v_cvt_pk_bf16_f32 v46, v39, 0
  v_cvt_pk_bf16_f32 v47, 0, v39
  v_dot2c_f32_bf16 v8, v124, v46
  v_dot2c_f32_bf16 v9, v124, v47
  v_dot2c_f32_bf16 v10, v125, v46
  v_dot2c_f32_bf16 v11, v125, v47
  v_dot2c_f32_bf16 v12, v126, v46
  v_dot2c_f32_bf16 v13, v126, v47
  v_dot2c_f32_bf16 v14, v127, v46
  v_dot2c_f32_bf16 v15, v127, v47
  s_mov_b32 s72, 16384
  buffer_load_dwordx4 v[136:139], v4, s[48:51], s72 offen
  s_waitcnt vmcnt(2)
  s_mov_b32 s72, 24576
  buffer_load_dwordx4 v[140:143], v4, s[48:51], s72 offen
  s_waitcnt vmcnt(2)
  s_mov_b32 s72, 32768
  buffer_load_dwordx4 v[144:147], v4, s[48:51], s72 offen
  s_waitcnt vmcnt(2)
  s_mov_b32 s72, 40960
  buffer_load_dwordx4 v[148:151], v4, s[48:51], s72 offen
  s_waitcnt vmcnt(2)
  s_mov_b32 s72, 49152
  buffer_load_dwordx4 v[152:155], v4, s[48:51], s72 offen
  s_waitcnt vmcnt(2)
  s_mov_b32 s72, 57344
  buffer_load_dwordx4 v[156:159], v4, s[48:51], s72 offen
  s_waitcnt vmcnt(2)
  s_mov_b32 s72, 65536
  buffer_load_dwordx4 v[160:163], v4, s[48:51], s72 offen
  s_waitcnt vmcnt(2)
  s_mov_b32 s72, 73728
  buffer_load_dwordx4 v[164:167], v4, s[48:51], s72 offen
  s_waitcnt vmcnt(2)
  s_mov_b32 s72, 81920
  buffer_load_dwordx4 v[168:171], v4, s[48:51], s72 offen
  s_waitcnt vmcnt(2)
  s_mov_b32 s72, 90112
  buffer_load_dwordx4 v[172:175], v4, s[48:51], s72 offen
  s_waitcnt vmcnt(2)
  s_mov_b32 s72, 98304
  buffer_load_dwordx4 v[176:179], v4, s[48:51], s72 offen
  s_waitcnt vmcnt(2)
  s_mov_b32 s72, 106496
  buffer_load_dwordx4 v[180:183], v4, s[48:51], s72 offen
  s_waitcnt vmcnt(2)
  s_mov_b32 s72, 114688
  buffer_load_dwordx4 v[184:187], v4, s[48:51], s72 offen
  s_waitcnt vmcnt(2)
  s_mov_b32 s72, 122880
  buffer_load_dwordx4 v[188:191], v4, s[48:51], s72 offen
  s_waitcnt vmcnt(2)
  s_mov_b32 s72, 2048
  buffer_load_dwordx4 v[192:195], v4, s[48:51], s72 offen
  s_waitcnt vmcnt(2)
  s_mov_b32 s72, 10240
  buffer_load_dwordx4 v[196:199], v4, s[48:51], s72 offen
  s_waitcnt vmcnt(2)
  s_mov_b32 s72, 18432
  buffer_load_dwordx4 v[200:203], v4, s[48:51], s72 offen
  s_waitcnt vmcnt(2)
  s_mov_b32 s72, 26624
  buffer_load_dwordx4 v[204:207], v4, s[48:51], s72 offen
  s_waitcnt vmcnt(2)
  s_mov_b32 s72, 34816
  buffer_load_dwordx4 v[208:211], v4, s[48:51], s72 offen
  s_waitcnt vmcnt(2)
  s_mov_b32 s72, 43008
  buffer_load_dwordx4 v[212:215], v4, s[48:51], s72 offen
  s_waitcnt vmcnt(2)
  s_mov_b32 s72, 51200
  buffer_load_dwordx4 v[216:219], v4, s[48:51], s72 offen
  s_waitcnt vmcnt(2)
  s_mov_b32 s72, 59392
  buffer_load_dwordx4 v[220:223], v4, s[48:51], s72 offen
  s_waitcnt vmcnt(2)
  s_mov_b32 s72, 67584
  buffer_load_dwordx4 v[224:227], v4, s[48:51], s72 offen
  s_waitcnt vmcnt(2)
  s_mov_b32 s72, 75776
  buffer_load_dwordx4 v[228:231], v4, s[48:51], s72 offen
  s_waitcnt vmcnt(2)
  s_mov_b32 s72, 83968
  buffer_load_dwordx4 v[232:235], v4, s[48:51], s72 offen
  s_waitcnt vmcnt(2)
  s_mov_b32 s72, 92160
  buffer_load_dwordx4 v[236:239], v4, s[48:51], s72 offen
  s_waitcnt vmcnt(2)
  s_mov_b32 s72, 100352
  buffer_load_dwordx4 v[240:243], v4, s[48:51], s72 offen
  s_waitcnt vmcnt(2)
  s_mov_b32 s72, 108544
  buffer_load_dwordx4 v[244:247], v4, s[48:51], s72 offen
  s_waitcnt vmcnt(2)
  s_mov_b32 s72, 116736
  buffer_load_dwordx4 v[248:251], v4, s[48:51], s72 offen
  s_waitcnt vmcnt(2)
  s_mov_b32 s72, 124928
  buffer_load_dwordx4 v[252:255], v4, s[48:51], s72 offen
  s_waitcnt vmcnt(2)
  s_cmp_eq_u32 s73, 1
  s_cbranch_scc0 L_nog
  v_mov_b32 v45, 0
  s_mov_b32 s79, 0x400000
L_spin9:
  ds_read_b32 v46, v45 offset:12560
  s_waitcnt lgkmcnt(0)
  v_readfirstlane_b32 s4, v46
  s_cmp_ge_u32 s4, 4
  s_cbranch_scc1 L_spun10
  s_sub_u32 s79, s79, 1
  s_cmp_eq_u32 s79, 0
  s_cbranch_scc1 L_spun10
  s_sleep 4
  s_branch L_spin9
L_spun10:
  v_mov_b32 v44, 0
  ds_read_b128 v[24:27], v44 offset:12416
  ds_read_b128 v[28:31], v44 offset:12432
  s_waitcnt lgkmcnt(0)
  v_max3_f32 v60, v24, v26, v28
  v_max_f32 v60, v60, v30
  v_sub_f32 v24, v24, v60
  v_sub_f32 v26, v26, v60
  v_sub_f32 v28, v28, v60
  v_sub_f32 v30, v30, v60
  v_mul_f32 v24, s77, v24
  v_mul_f32 v26, s77, v26
  v_mul_f32 v28, s77, v28
  v_mul_f32 v30, s77, v30
  v_exp_f32 v24, v24
  v_exp_f32 v26, v26
  v_exp_f32 v28, v28
  v_exp_f32 v30, v30
  s_nop 0
  v_mul_f32 v61, v24, v25
  v_fmac_f32 v61, v26, v27
  v_fmac_f32 v61, v28, v29
  v_fmac_f32 v61, v30, v31
  s_mov_b64 exec, 1
  v_mov_b32 v48, v60
  v_mov_b32 v49, s43
  v_mov_b32 v50, v61
  v_mov_b32 v51, s43
  global_store_dwordx4 v44, v[48:51], s[66:67] sc1
  s_mov_b32 s79, 0x20000
L_ppoll:
  global_load_dwordx4 v[24:27], v44, s[68:69] sc1
  s_waitcnt vmcnt(0)
  v_xor_b32 v52, s43, v25
  v_xor_b32 v53, s43, v27
  v_or_b32 v52, v52, v53
  s_nop 0
  v_readfirstlane_b32 s4, v52
  s_cmp_eq_u32 s4, 0
  s_cbranch_scc1 L_pokk
  s_sub_u32 s79, s79, 1
  s_cmp_eq_u32 s79, 0
  s_cbranch_scc1 L_pokk
  s_sleep 4
  s_branch L_ppoll
L_pokk:
  v_mov_b32 v58, v24
  v_mov_b32 v59, v26
L_pok:
  v_max_f32 v48, v60, v58
  v_sub_f32 v49, v60, v48
  v_sub_f32 v50, v58, v48
  v_mul_f32 v49, s77, v49
  v_mul_f32 v50, s77, v50
  v_exp_f32 v49, v49
  v_exp_f32 v50, v50
  s_nop 0
  v_mul_f32 v51, v61, v49
  v_fmac_f32 v51, v59, v50
  v_rcp_f32 v52, v51
  s_nop 0
  v_fma_f32 v53, -v51, v52, 1.0
  v_fma_f32 v49, v53, v52, v52
  v_mov_b32 v50, 1
  v_mov_b32 v52, 0
  ds_write_b64 v52, v[48:49] offset:12480
  ds_write_b32 v52, v50 offset:12488
  s_mov_b64 exec, -1
L_nog:
  s_waitcnt vmcnt(0)
  s_mov_b32 s4, 0x05040100
  s_mov_b32 s5, 0x07060302
  v_perm_b32 v52, v132, v128, s4
  v_perm_b32 v53, v133, v129, s4
  v_perm_b32 v54, v134, v130, s4
  v_perm_b32 v55, v135, v131, s4
  v_perm_b32 v132, v132, v128, s5
  v_perm_b32 v133, v133, v129, s5
  v_perm_b32 v134, v134, v130, s5
  v_perm_b32 v135, v135, v131, s5
  v_perm_b32 v128, v140, v136, s4
  v_perm_b32 v129, v141, v137, s4
  v_perm_b32 v130, v142, v138, s4
  v_perm_b32 v131, v143, v139, s4
  v_perm_b32 v140, v140, v136, s5
  v_perm_b32 v141, v141, v137, s5
  v_perm_b32 v142, v142, v138, s5
  v_perm_b32 v143, v143, v139, s5
  v_perm_b32 v136, v148, v144, s4
  v_perm_b32 v137, v149, v145, s4
  v_perm_b32 v138, v150, v146, s4
  v_perm_b32 v139, v151, v147, s4
  v_perm_b32 v148, v148, v144, s5
  v_perm_b32 v149, v149, v145, s5
  v_perm_b32 v150, v150, v146, s5
  v_perm_b32 v151, v151, v147, s5
  v_perm_b32 v144, v156, v152, s4
  v_perm_b32 v145, v157, v153, s4
  v_perm_b32 v146, v158, v154, s4
  v_perm_b32 v147, v159, v155, s4
  v_perm_b32 v156, v156, v152, s5
  v_perm_b32 v157, v157, v153, s5
  v_perm_b32 v158, v158, v154, s5
  v_perm_b32 v159, v159, v155, s5
  v_perm_b32 v152, v164, v160, s4
  v_perm_b32 v153, v165, v161, s4
  v_perm_b32 v154, v166, v162, s4
  v_perm_b32 v155, v167, v163, s4
  v_perm_b32 v164, v164, v160, s5
  v_perm_b32 v165, v165, v161, s5
  v_perm_b32 v166, v166, v162, s5
  v_perm_b32 v167, v167, v163, s5
  v_perm_b32 v160, v172, v168, s4
  v_perm_b32 v161, v173, v169, s4
  v_perm_b32 v162, v174, v170, s4
  v_perm_b32 v163, v175, v171, s4
  v_perm_b32 v172, v172, v168, s5
  v_perm_b32 v173, v173, v169, s5
  v_perm_b32 v174, v174, v170, s5
  v_perm_b32 v175, v175, v171, s5
  v_perm_b32 v168, v180, v176, s4
  v_perm_b32 v169, v181, v177, s4
  v_perm_b32 v170, v182, v178, s4
  v_perm_b32 v171, v183, v179, s4
  v_perm_b32 v180, v180, v176, s5
  v_perm_b32 v181, v181, v177, s5
  v_perm_b32 v182, v182, v178, s5
  v_perm_b32 v183, v183, v179, s5
  v_perm_b32 v176, v188, v184, s4
  v_perm_b32 v177, v189, v185, s4
  v_perm_b32 v178, v190, v186, s4
  v_perm_b32 v179, v191, v187, s4
  v_perm_b32 v188, v188, v184, s5
  v_perm_b32 v189, v189, v185, s5
  v_perm_b32 v190, v190, v186, s5
  v_perm_b32 v191, v191, v187, s5
  v_perm_b32 v184, v196, v192, s4
  v_perm_b32 v185, v197, v193, s4
  v_perm_b32 v186, v198, v194, s4
  v_perm_b32 v187, v199, v195, s4
  v_perm_b32 v196, v196, v192, s5
  v_perm_b32 v197, v197, v193, s5
  v_perm_b32 v198, v198, v194, s5
  v_perm_b32 v199, v199, v195, s5
  v_perm_b32 v192, v204, v200, s4
  v_perm_b32 v193, v205, v201, s4
  v_perm_b32 v194, v206, v202, s4
  v_perm_b32 v195, v207, v203, s4
  v_perm_b32 v204, v204, v200, s5
  v_perm_b32 v205, v205, v201, s5
  v_perm_b32 v206, v206, v202, s5
  v_perm_b32 v207, v207, v203, s5
  v_perm_b32 v200, v212, v208, s4
  v_perm_b32 v201, v213, v209, s4
  v_perm_b32 v202, v214, v210, s4
  v_perm_b32 v203, v215, v211, s4
  v_perm_b32 v212, v212, v208, s5
  v_perm_b32 v213, v213, v209, s5
  v_perm_b32 v214, v214, v210, s5
  v_perm_b32 v215, v215, v211, s5
  v_perm_b32 v208, v220, v216, s4
  v_perm_b32 v209, v221, v217, s4
  v_perm_b32 v210, v222, v218, s4
  v_perm_b32 v211, v223, v219, s4
  v_perm_b32 v220, v220, v216, s5
  v_perm_b32 v221, v221, v217, s5
  v_perm_b32 v222, v222, v218, s5
  v_perm_b32 v223, v223, v219, s5
  v_perm_b32 v216, v228, v224, s4
  v_perm_b32 v217, v229, v225, s4
  v_perm_b32 v218, v230, v226, s4
  v_perm_b32 v219, v231, v227, s4
  v_perm_b32 v228, v228, v224, s5
  v_perm_b32 v229, v229, v225, s5
  v_perm_b32 v230, v230, v226, s5
  v_perm_b32 v231, v231, v227, s5
  v_perm_b32 v224, v236, v232, s4
  v_perm_b32 v225, v237, v233, s4
  v_perm_b32 v226, v238, v234, s4
  v_perm_b32 v227, v239, v235, s4
  v_perm_b32 v236, v236, v232, s5
  v_perm_b32 v237, v237, v233, s5
  v_perm_b32 v238, v238, v234, s5
  v_perm_b32 v239, v239, v235, s5
  v_perm_b32 v232, v244, v240, s4
  v_perm_b32 v233, v245, v241, s4
  v_perm_b32 v234, v246, v242, s4
  v_perm_b32 v235, v247, v243, s4
  v_perm_b32 v244, v244, v240, s5
  v_perm_b32 v245, v245, v241, s5
  v_perm_b32 v246, v246, v242, s5
  v_perm_b32 v247, v247, v243, s5
  v_perm_b32 v240, v252, v248, s4
  v_perm_b32 v241, v253, v249, s4
  v_perm_b32 v242, v254, v250, s4
  v_perm_b32 v243, v255, v251, s4
  v_perm_b32 v252, v252, v248, s5
  v_perm_b32 v253, v253, v249, s5
  v_perm_b32 v254, v254, v250, s5
  v_perm_b32 v255, v255, v251, s5
  v_lshlrev_b32 v62, 3, v0
  v_lshrrev_b32 v56, 2, v0
  v_lshlrev_b32 v56, 12, v56
  v_and_b32 v57, 3, v0
  v_lshl_add_u32 v56, v57, 4, v56
  v_add_u32 v57, 65536, v56
  v_add_u32 v58, 131072, v56
  v_add_u32 v59, 196608, v56
  v_and_b32 v60, 3, v0
  v_lshlrev_b32 v60, 2, v60
  v_lshrrev_b32 v61, 5, v0
  v_lshl_add_u32 v60, v61, 1, v60
  v_lshlrev_b32 v61, 16, v6
  v_mov_b32 v45, 0
  s_mov_b32 s79, 0x400000
L_spin11:
  ds_read_b32 v46, v45 offset:12564
  s_waitcnt lgkmcnt(0)
  v_readfirstlane_b32 s4, v46
  s_cmp_ge_u32 s4, 4
  s_cbranch_scc1 L_spun12
  s_sub_u32 s79, s79, 1
  s_cmp_eq_u32 s79, 0
  s_cbranch_scc1 L_spun12
  s_branch L_spin11
L_spun12:
  ds_read_b64 v[16:17], v62 offset:14336
  ds_read_b64 v[18:19], v62 offset:14848
  ds_read_b64 v[20:21], v62 offset:15360
  ds_read_b64 v[22:23], v62 offset:15872
  s_waitcnt lgkmcnt(0)
  v_add_f32 v16, v16, v18
  v_add_f32 v17, v17, v19
  v_add_f32 v20, v20, v22
  v_add_f32 v21, v21, v23
  v_add_f32 v16, v16, v20
  v_add_f32 v17, v17, v21
  v_cvt_pk_bf16_f32 v16, v16, v17
  s_nop 1
  v_dot2c_f32_bf16_dpp v8, v16, v52 row_newbcast:0 row_mask:0xf bank_mask:0xf
  v_dot2c_f32_bf16_dpp v9, v16, v132 row_newbcast:0 row_mask:0xf bank_mask:0xf
  v_dot2c_f32_bf16_dpp v10, v16, v53 row_newbcast:0 row_mask:0xf bank_mask:0xf
  v_dot2c_f32_bf16_dpp v11, v16, v133 row_newbcast:0 row_mask:0xf bank_mask:0xf
  v_dot2c_f32_bf16_dpp v12, v16, v54 row_newbcast:0 row_mask:0xf bank_mask:0xf
  v_dot2c_f32_bf16_dpp v13, v16, v134 row_newbcast:0 row_mask:0xf bank_mask:0xf
  v_dot2c_f32_bf16_dpp v14, v16, v55 row_newbcast:0 row_mask:0xf bank_mask:0xf
  v_dot2c_f32_bf16_dpp v15, v16, v135 row_newbcast:0 row_mask:0xf bank_mask:0xf
  v_dot2c_f32_bf16_dpp v8, v16, v128 row_newbcast:1 row_mask:0xf bank_mask:0xf
  v_dot2c_f32_bf16_dpp v9, v16, v140 row_newbcast:1 row_mask:0xf bank_mask:0xf
  v_dot2c_f32_bf16_dpp v10, v16, v129 row_newbcast:1 row_mask:0xf bank_mask:0xf
  v_dot2c_f32_bf16_dpp v11, v16, v141 row_newbcast:1 row_mask:0xf bank_mask:0xf
  v_dot2c_f32_bf16_dpp v12, v16, v130 row_newbcast:1 row_mask:0xf bank_mask:0xf
  v_dot2c_f32_bf16_dpp v13, v16, v142 row_newbcast:1 row_mask:0xf bank_mask:0xf
  v_dot2c_f32_bf16_dpp v14, v16, v131 row_newbcast:1 row_mask:0xf bank_mask:0xf
  v_dot2c_f32_bf16_dpp v15, v16, v143 row_newbcast:1 row_mask:0xf bank_mask:0xf
  v_dot2c_f32_bf16_dpp v8, v16, v136 row_newbcast:2 row_mask:0xf bank_mask:0xf
  v_dot2c_f32_bf16_dpp v9, v16, v148 row_newbcast:2 row_mask:0xf bank_mask:0xf
  v_dot2c_f32_bf16_dpp v10, v16, v137 row_newbcast:2 row_mask:0xf bank_mask:0xf
  v_dot2c_f32_bf16_dpp v11, v16, v149 row_newbcast:2 row_mask:0xf bank_mask:0xf
  v_dot2c_f32_bf16_dpp v12, v16, v138 row_newbcast:2 row_mask:0xf bank_mask:0xf
  v_dot2c_f32_bf16_dpp v13, v16, v150 row_newbcast:2 row_mask:0xf bank_mask:0xf
  v_dot2c_f32_bf16_dpp v14, v16, v139 row_newbcast:2 row_mask:0xf bank_mask:0xf
  v_dot2c_f32_bf16_dpp v15, v16, v151 row_newbcast:2 row_mask:0xf bank_mask:0xf
  v_dot2c_f32_bf16_dpp v8, v16, v144 row_newbcast:3 row_mask:0xf bank_mask:0xf
  v_dot2c_f32_bf16_dpp v9, v16, v156 row_newbcast:3 row_mask:0xf bank_mask:0xf
  v_dot2c_f32_bf16_dpp v10, v16, v145 row_newbcast:3 row_mask:0xf bank_mask:0xf
  v_dot2c_f32_bf16_dpp v11, v16, v157 row_newbcast:3 row_mask:0xf bank_mask:0xf
  v_dot2c_f32_bf16_dpp v12, v16, v146 row_newbcast:3 row_mask:0xf bank_mask:0xf
  v_dot2c_f32_bf16_dpp v13, v16, v158 row_newbcast:3 row_mask:0xf bank_mask:0xf
  v_dot2c_f32_bf16_dpp v14, v16, v147 row_newbcast:3 row_mask:0xf bank_mask:0xf
  v_dot2c_f32_bf16_dpp v15, v16, v159 row_newbcast:3 row_mask:0xf bank_mask:0xf
  v_dot2c_f32_bf16_dpp v8, v16, v152 row_newbcast:4 row_mask:0xf bank_mask:0xf
  v_dot2c_f32_bf16_dpp v9, v16, v164 row_newbcast:4 row_mask:0xf bank_mask:0xf
  v_dot2c_f32_bf16_dpp v10, v16, v153 row_newbcast:4 row_mask:0xf bank_mask:0xf
  v_dot2c_f32_bf16_dpp v11, v16, v165 row_newbcast:4 row_mask:0xf bank_mask:0xf
  v_dot2c_f32_bf16_dpp v12, v16, v154 row_newbcast:4 row_mask:0xf bank_mask:0xf
  v_dot2c_f32_bf16_dpp v13, v16, v166 row_newbcast:4 row_mask:0xf bank_mask:0xf
  v_dot2c_f32_bf16_dpp v14, v16, v155 row_newbcast:4 row_mask:0xf bank_mask:0xf
  v_dot2c_f32_bf16_dpp v15, v16, v167 row_newbcast:4 row_mask:0xf bank_mask:0xf
  v_dot2c_f32_bf16_dpp v8, v16, v160 row_newbcast:5 row_mask:0xf bank_mask:0xf
  v_dot2c_f32_bf16_dpp v9, v16, v172 row_newbcast:5 row_mask:0xf bank_mask:0xf
  v_dot2c_f32_bf16_dpp v10, v16, v161 row_newbcast:5 row_mask:0xf bank_mask:0xf
  v_dot2c_f32_bf16_dpp v11, v16, v173 row_newbcast:5 row_mask:0xf bank_mask:0xf
  v_dot2c_f32_bf16_dpp v12, v16, v162 row_newbcast:5 row_mask:0xf bank_mask:0xf
  v_dot2c_f32_bf16_dpp v13, v16, v174 row_newbcast:5 row_mask:0xf bank_mask:0xf
  v_dot2c_f32_bf16_dpp v14, v16, v163 row_newbcast:5 row_mask:0xf bank_mask:0xf
  v_dot2c_f32_bf16_dpp v15, v16, v175 row_newbcast:5 row_mask:0xf bank_mask:0xf
  v_dot2c_f32_bf16_dpp v8, v16, v168 row_newbcast:6 row_mask:0xf bank_mask:0xf
  v_dot2c_f32_bf16_dpp v9, v16, v180 row_newbcast:6 row_mask:0xf bank_mask:0xf
  v_dot2c_f32_bf16_dpp v10, v16, v169 row_newbcast:6 row_mask:0xf bank_mask:0xf
  v_dot2c_f32_bf16_dpp v11, v16, v181 row_newbcast:6 row_mask:0xf bank_mask:0xf
  v_dot2c_f32_bf16_dpp v12, v16, v170 row_newbcast:6 row_mask:0xf bank_mask:0xf
  v_dot2c_f32_bf16_dpp v13, v16, v182 row_newbcast:6 row_mask:0xf bank_mask:0xf
  v_dot2c_f32_bf16_dpp v14, v16, v171 row_newbcast:6 row_mask:0xf bank_mask:0xf
  v_dot2c_f32_bf16_dpp v15, v16, v183 row_newbcast:6 row_mask:0xf bank_mask:0xf
  v_dot2c_f32_bf16_dpp v8, v16, v176 row_newbcast:7 row_mask:0xf bank_mask:0xf
  v_dot2c_f32_bf16_dpp v9, v16, v188 row_newbcast:7 row_mask:0xf bank_mask:0xf
  v_dot2c_f32_bf16_dpp v10, v16, v177 row_newbcast:7 row_mask:0xf bank_mask:0xf
  v_dot2c_f32_bf16_dpp v11, v16, v189 row_newbcast:7 row_mask:0xf bank_mask:0xf
  v_dot2c_f32_bf16_dpp v12, v16, v178 row_newbcast:7 row_mask:0xf bank_mask:0xf
  v_dot2c_f32_bf16_dpp v13, v16, v190 row_newbcast:7 row_mask:0xf bank_mask:0xf
  v_dot2c_f32_bf16_dpp v14, v16, v179 row_newbcast:7 row_mask:0xf bank_mask:0xf
  v_dot2c_f32_bf16_dpp v15, v16, v191 row_newbcast:7 row_mask:0xf bank_mask:0xf
  v_dot2c_f32_bf16_dpp v8, v16, v184 row_newbcast:8 row_mask:0xf bank_mask:0xf
  v_dot2c_f32_bf16_dpp v9, v16, v196 row_newbcast:8 row_mask:0xf bank_mask:0xf
  v_dot2c_f32_bf16_dpp v10, v16, v185 row_newbcast:8 row_mask:0xf bank_mask:0xf
  v_dot2c_f32_bf16_dpp v11, v16, v197 row_newbcast:8 row_mask:0xf bank_mask:0xf
  v_dot2c_f32_bf16_dpp v12, v16, v186 row_newbcast:8 row_mask:0xf bank_mask:0xf
  v_dot2c_f32_bf16_dpp v13, v16, v198 row_newbcast:8 row_mask:0xf bank_mask:0xf
  v_dot2c_f32_bf16_dpp v14, v16, v187 row_newbcast:8 row_mask:0xf bank_mask:0xf
  v_dot2c_f32_bf16_dpp v15, v16, v199 row_newbcast:8 row_mask:0xf bank_mask:0xf
  v_dot2c_f32_bf16_dpp v8, v16, v192 row_newbcast:9 row_mask:0xf bank_mask:0xf
  v_dot2c_f32_bf16_dpp v9, v16, v204 row_newbcast:9 row_mask:0xf bank_mask:0xf
  v_dot2c_f32_bf16_dpp v10, v16, v193 row_newbcast:9 row_mask:0xf bank_mask:0xf
  v_dot2c_f32_bf16_dpp v11, v16, v205 row_newbcast:9 row_mask:0xf bank_mask:0xf
  v_dot2c_f32_bf16_dpp v12, v16, v194 row_newbcast:9 row_mask:0xf bank_mask:0xf
  v_dot2c_f32_bf16_dpp v13, v16, v206 row_newbcast:9 row_mask:0xf bank_mask:0xf
  v_dot2c_f32_bf16_dpp v14, v16, v195 row_newbcast:9 row_mask:0xf bank_mask:0xf
  v_dot2c_f32_bf16_dpp v15, v16, v207 row_newbcast:9 row_mask:0xf bank_mask:0xf
  v_dot2c_f32_bf16_dpp v8, v16, v200 row_newbcast:10 row_mask:0xf bank_mask:0xf
  v_dot2c_f32_bf16_dpp v9, v16, v212 row_newbcast:10 row_mask:0xf bank_mask:0xf
  v_dot2c_f32_bf16_dpp v10, v16, v201 row_newbcast:10 row_mask:0xf bank_mask:0xf
  v_dot2c_f32_bf16_dpp v11, v16, v213 row_newbcast:10 row_mask:0xf bank_mask:0xf
  v_dot2c_f32_bf16_dpp v12, v16, v202 row_newbcast:10 row_mask:0xf bank_mask:0xf
  v_dot2c_f32_bf16_dpp v13, v16, v214 row_newbcast:10 row_mask:0xf bank_mask:0xf
  v_dot2c_f32_bf16_dpp v14, v16, v203 row_newbcast:10 row_mask:0xf bank_mask:0xf
  v_dot2c_f32_bf16_dpp v15, v16, v215 row_newbcast:10 row_mask:0xf bank_mask:0xf
  v_dot2c_f32_bf16_dpp v8, v16, v208 row_newbcast:11 row_mask:0xf bank_mask:0xf
  v_dot2c_f32_bf16_dpp v9, v16, v220 row_newbcast:11 row_mask:0xf bank_mask:0xf
  v_dot2c_f32_bf16_dpp v10, v16, v209 row_newbcast:11 row_mask:0xf bank_mask:0xf
  v_dot2c_f32_bf16_dpp v11, v16, v221 row_newbcast:11 row_mask:0xf bank_mask:0xf
  v_dot2c_f32_bf16_dpp v12, v16, v210 row_newbcast:11 row_mask:0xf bank_mask:0xf
  v_dot2c_f32_bf16_dpp v13, v16, v222 row_newbcast:11 row_mask:0xf bank_mask:0xf
  v_dot2c_f32_bf16_dpp v14, v16, v211 row_newbcast:11 row_mask:0xf bank_mask:0xf
  v_dot2c_f32_bf16_dpp v15, v16, v223 row_newbcast:11 row_mask:0xf bank_mask:0xf
  v_dot2c_f32_bf16_dpp v8, v16, v216 row_newbcast:12 row_mask:0xf bank_mask:0xf
  v_dot2c_f32_bf16_dpp v9, v16, v228 row_newbcast:12 row_mask:0xf bank_mask:0xf
  v_dot2c_f32_bf16_dpp v10, v16, v217 row_newbcast:12 row_mask:0xf bank_mask:0xf
  v_dot2c_f32_bf16_dpp v11, v16, v229 row_newbcast:12 row_mask:0xf bank_mask:0xf
  v_dot2c_f32_bf16_dpp v12, v16, v218 row_newbcast:12 row_mask:0xf bank_mask:0xf
  v_dot2c_f32_bf16_dpp v13, v16, v230 row_newbcast:12 row_mask:0xf bank_mask:0xf
  v_dot2c_f32_bf16_dpp v14, v16, v219 row_newbcast:12 row_mask:0xf bank_mask:0xf
  v_dot2c_f32_bf16_dpp v15, v16, v231 row_newbcast:12 row_mask:0xf bank_mask:0xf
  v_dot2c_f32_bf16_dpp v8, v16, v224 row_newbcast:13 row_mask:0xf bank_mask:0xf
  v_dot2c_f32_bf16_dpp v9, v16, v236 row_newbcast:13 row_mask:0xf bank_mask:0xf
  v_dot2c_f32_bf16_dpp v10, v16, v225 row_newbcast:13 row_mask:0xf bank_mask:0xf
  v_dot2c_f32_bf16_dpp v11, v16, v237 row_newbcast:13 row_mask:0xf bank_mask:0xf
  v_dot2c_f32_bf16_dpp v12, v16, v226 row_newbcast:13 row_mask:0xf bank_mask:0xf
  v_dot2c_f32_bf16_dpp v13, v16, v238 row_newbcast:13 row_mask:0xf bank_mask:0xf
  v_dot2c_f32_bf16_dpp v14, v16, v227 row_newbcast:13 row_mask:0xf bank_mask:0xf
  v_dot2c_f32_bf16_dpp v15, v16, v239 row_newbcast:13 row_mask:0xf bank_mask:0xf
  v_dot2c_f32_bf16_dpp v8, v16, v232 row_newbcast:14 row_mask:0xf bank_mask:0xf
  v_dot2c_f32_bf16_dpp v9, v16, v244 row_newbcast:14 row_mask:0xf bank_mask:0xf
  v_dot2c_f32_bf16_dpp v10, v16, v233 row_newbcast:14 row_mask:0xf bank_mask:0xf
  v_dot2c_f32_bf16_dpp v11, v16, v245 row_newbcast:14 row_mask:0xf bank_mask:0xf
  v_dot2c_f32_bf16_dpp v12, v16, v234 row_newbcast:14 row_mask:0xf bank_mask:0xf
  v_dot2c_f32_bf16_dpp v13, v16, v246 row_newbcast:14 row_mask:0xf bank_mask:0xf
  v_dot2c_f32_bf16_dpp v14, v16, v235 row_newbcast:14 row_mask:0xf bank_mask:0xf
  v_dot2c_f32_bf16_dpp v15, v16, v247 row_newbcast:14 row_mask:0xf bank_mask:0xf
  v_dot2c_f32_bf16_dpp v8, v16, v240 row_newbcast:15 row_mask:0xf bank_mask:0xf
  v_dot2c_f32_bf16_dpp v9, v16, v252 row_newbcast:15 row_mask:0xf bank_mask:0xf
  v_dot2c_f32_bf16_dpp v10, v16, v241 row_newbcast:15 row_mask:0xf bank_mask:0xf
  v_dot2c_f32_bf16_dpp v11, v16, v253 row_newbcast:15 row_mask:0xf bank_mask:0xf
  v_dot2c_f32_bf16_dpp v12, v16, v242 row_newbcast:15 row_mask:0xf bank_mask:0xf
  v_dot2c_f32_bf16_dpp v13, v16, v254 row_newbcast:15 row_mask:0xf bank_mask:0xf
  v_dot2c_f32_bf16_dpp v14, v16, v243 row_newbcast:15 row_mask:0xf bank_mask:0xf
  v_dot2c_f32_bf16_dpp v15, v16, v255 row_newbcast:15 row_mask:0xf bank_mask:0xf
  s_nop 3
  v_permlane32_swap_b32 v8, v12
  v_permlane32_swap_b32 v9, v13
  v_permlane32_swap_b32 v10, v14
  v_permlane32_swap_b32 v11, v15
  s_nop 1
  v_add_f32 v8, v8, v12
  v_add_f32 v10, v10, v14
  v_add_f32 v9, v9, v13
  v_add_f32 v11, v11, v15
  s_nop 1
  v_permlane16_swap_b32 v8, v10
  v_permlane16_swap_b32 v9, v11
  s_nop 1
  v_add_f32 v8, v8, v10
  v_add_f32 v9, v9, v11
  v_mov_b32 v10, v9
  v_mov_b32 v9, s43
  v_mov_b32 v11, s43
  global_store_dwordx4 v7, v[8:11], s[62:63] sc1
  s_cmp_eq_u32 s73, 2
  s_cbranch_scc0 L_fin
  s_mov_b32 s79, 0x20000
  s_mov_b64 s[44:45], -1
  s_mov_b64 s[46:47], -1
  s_mov_b64 s[48:49], -1
  s_mov_b64 s[50:51], -1
L_ypoll:
  s_mov_b64 exec, s[44:45]
  s_cbranch_execz L_yskip0
  global_load_dwordx4 v[64:67], v56, s[64:65] sc1
L_yskip0:
  s_mov_b64 exec, s[46:47]
  s_cbranch_execz L_yskip1
  global_load_dwordx4 v[68:71], v57, s[64:65] sc1
L_yskip1:
  s_mov_b64 exec, s[48:49]
  s_cbranch_execz L_yskip2
  global_load_dwordx4 v[72:75], v58, s[64:65] sc1
L_yskip2:
  s_mov_b64 exec, s[50:51]
  s_cbranch_execz L_yskip3
  global_load_dwordx4 v[76:79], v59, s[64:65] sc1
L_yskip3:
  s_mov_b64 exec, -1
  s_waitcnt vmcnt(0)
  v_xor_b32 v53, s43, v65
  v_xor_b32 v54, s43, v67
  v_or_b32 v53, v53, v54
  v_cmp_ne_u32 s[44:45], 0, v53
  v_xor_b32 v53, s43, v69
  v_xor_b32 v54, s43, v71
  v_or_b32 v53, v53, v54
  v_cmp_ne_u32 s[46:47], 0, v53
  v_xor_b32 v53, s43, v73
  v_xor_b32 v54, s43, v75
  v_or_b32 v53, v53, v54
  v_cmp_ne_u32 s[48:49], 0, v53
  v_xor_b32 v53, s43, v77
  v_xor_b32 v54, s43, v79
  v_or_b32 v53, v53, v54
  v_cmp_ne_u32 s[50:51], 0, v53
  s_nop 1
  s_or_b64 s[4:5], s[44:45], s[46:47]
  s_or_b64 s[6:7], s[48:49], s[50:51]
  s_or_b64 s[4:5], s[4:5], s[6:7]
  s_cbranch_scc0 L_yok
  s_sub_u32 s79, s79, 1
  s_cmp_eq_u32 s79, 0
  s_cbranch_scc1 L_yok
  s_sleep 1
  s_branch L_ypoll
L_yok:
  v_add_f32 v64, v64, v68
  v_add_f32 v66, v66, v70
  v_add_f32 v72, v72, v76
  v_add_f32 v74, v74, v78
  v_add_f32 v64, v64, v72
  v_add_f32 v66, v66, v74
  s_nop 1
  v_permlane32_swap_b32 v64, v66
  s_nop 1
  v_add_f32 v64, v64, v66
  v_mov_b32 v66, v64
  s_nop 1
  v_permlane16_swap_b32 v64, v66
  s_nop 1
  v_add_f32 v64, v64, v66
  s_nop 1
  v_add_f32_dpp v64, v64, v64 row_ror:8 row_mask:0xf bank_mask:0xf
  s_nop 1
  v_add_f32_dpp v64, v64, v64 row_ror:4 row_mask:0xf bank_mask:0xf
  v_add_f32 v64, v64, v61
  v_cvt_pk_bf16_f32 v64, v64, v64
  s_mov_b32 exec_lo, 0xf
  s_mov_b32 exec_hi, 0xf
  global_store_short v60, v64, s[70:71]
  s_cmp_eq_u32 s2, 0
  s_cbranch_scc0 L_fin
  s_cmp_eq_u32 s73, 2
  s_cbranch_scc0 L_fin
  s_mov_b64 exec, 1
  s_add_u32 s6, s28, 0x2f0000
  s_addc_u32 s7, s29, 0
  v_mov_b32 v48, 0
  v_mov_b32 v49, s43
  global_store_dword v48, v49, s[6:7] sc1
L_fin:
L_end:
  s_endpgm
.section .rodata,"a"
.p2align 6
.amdhsa_kernel parallel_sum__sliding_block_cached__dense_activation_silu__decode_kernel
  .amdhsa_next_free_vgpr 256
  .amdhsa_next_free_sgpr 102
  .amdhsa_accum_offset 256
  .amdhsa_group_segment_fixed_size 0
  .amdhsa_kernarg_size 88
  .amdhsa_user_sgpr_count 2
  .amdhsa_user_sgpr_kernarg_segment_ptr 1
  .amdhsa_system_sgpr_workgroup_id_x 1
.end_amdhsa_kernel
```
